```python
import torch

def _softmax(x, axis=-1):
    return torch.softmax(x, dim=axis)
def _gelu(x):
    return torch.nn.functional.gelu(x, approximate="tanh")
def _silu(x):
    return torch.nn.functional.silu(x)
def _sigmoid(x):
    return torch.sigmoid(x)
def _layernorm(x, axis=-1, eps=1e-5):
    m = x.mean(dim=axis, keepdim=True)
    v = x.var(dim=axis, keepdim=True, unbiased=False)
    return (x - m) / torch.sqrt(v + eps)
def _scatter_add(tgt, idx, src, axis=0):
    return tgt.clone().index_add_(axis, idx, src)
def _segment_sum(src, seg, n):
    out = torch.zeros((n,) + src.shape[1:], dtype=src.dtype)
    return out.index_add_(0, seg, src)
def _pad(x, pw):
    flat = tuple(v for pair in reversed(pw) for v in pair)
    return torch.nn.functional.pad(x, flat)

kernel_name = 'gather_scatter__cheap_equivariant_egnn__graph'

def setup_inputs():

    _w = (lambda a: (lambda t: t.to(torch.bfloat16) if t.is_floating_point() else t)(torch.as_tensor(a)))
    N, deg, D, De = 10000, 64, 64, max(4, 1)
    E = N * deg
    return {
        "h": _w((lambda *s: torch.randn(*s, dtype=torch.bfloat16) * 0.2)(N, D)),
        "pos": _w((lambda *s: torch.randn(*s, dtype=torch.bfloat16) * 0.8)(N, 3)),
        "e_attr": _w((lambda *s: torch.randn(*s, dtype=torch.bfloat16) * 0.8)(E, De)),
        "src": _w((lambda lo, hi, *s: torch.randint(lo, hi, s))(0, N, E).to(torch.int64)),
        "dst": _w((lambda lo, hi, *s: torch.randint(lo, hi, s))(0, N, E).to(torch.int64)),
        "w_e": _w(0.1 * (lambda *s: torch.randn(*s, dtype=torch.bfloat16) * 0.8)(2 * D + 1 + De, D)),
        "w_x": _w(0.1 * (lambda *s: torch.randn(*s, dtype=torch.bfloat16) * 0.2)(D, 1)),
        "w_h": _w(0.1 * (lambda *s: torch.randn(*s, dtype=torch.bfloat16) * 0.2)(2 * D, D)),
    }

def reference(h, pos, e_attr, src, dst, w_e, w_x, w_h):
    N, D = h.shape[0], h.shape[1]
    diff = pos[dst] - pos[src]
    dist2 = torch.sum(diff * diff, axis=-1, keepdims=True)
    e_in = torch.concatenate([h[dst], h[src], dist2, e_attr], axis=-1)
    m_ij = _silu(e_in @ w_e)
    coord_scale = m_ij @ w_x
    pos_new = pos + _segment_sum(diff * coord_scale, dst, N)
    m_i = _segment_sum(m_ij, dst, N)
    h_new = h + _silu(torch.concatenate([h, m_i], axis=-1) @ w_h)
    return h_new, pos_new
```

```asm
; @launch grid=(256,1,1) block=(512,1,1) lds=159744
.amdgcn_target "amdgcn-amd-amdhsa--gfx950"
.text
.globl gather_scatter__cheap_equivariant_egnn__graph_kernel
.p2align 8
.type gather_scatter__cheap_equivariant_egnn__graph_kernel,@function
gather_scatter__cheap_equivariant_egnn__graph_kernel:
  s_cmp_ge_u32 s2, 256
  s_cbranch_scc1 L_done
  s_load_dwordx2 s[68:69], s[0:1], 32
  s_load_dwordx2 s[64:65], s[0:1], 24
  s_load_dwordx2 s[36:37], s[0:1], 80
  s_load_dwordx2 s[72:73], s[0:1], 40
  s_load_dwordx2 s[76:77], s[0:1], 56
  s_load_dwordx2 s[84:85], s[0:1], 0
  s_load_dwordx2 s[40:41], s[0:1], 8
  s_load_dwordx2 s[32:33], s[0:1], 16
  s_load_dwordx2 s[48:49], s[0:1], 64
  s_load_dwordx2 s[16:17], s[0:1], 48
  v_and_b32 v1, 63, v0
  v_lshrrev_b32 v3, 6, v0
  v_lshlrev_b32 v2, 4, v0
  v_readfirstlane_b32 s3, v3
  v_lshlrev_b32 v3, 2, v0
  v_lshlrev_b32 v248, 2, v1
  v_mov_b32 v8, 4
  s_movk_i32 s56, 452
  v_cmp_gt_u32 s[88:89], s56, v0
  s_mov_b32 s100, 10518528
  s_mov_b32 s70, 2560000
  s_mov_b32 s71, 0x20000
  s_mov_b32 s66, 2560000
  s_mov_b32 s67, 0x20000
  s_mov_b32 s38, 10518592
  s_mov_b32 s39, 0x20000
  s_mov_b32 s74, 17024
  s_mov_b32 s75, 0x20000
  s_mov_b32 s78, 16384
  s_mov_b32 s79, 0x20000
  s_mov_b32 s86, 1280000
  s_mov_b32 s87, 0x20000
  s_mov_b32 s42, 60000
  s_mov_b32 s43, 0x20000
  s_and_b32 s26, s2, 7
  s_lshl_b32 s26, s26, 5
  s_lshr_b32 s56, s2, 3
  s_add_u32 s26, s26, s56
  s_mul_i32 s14, s26, 10000
  s_add_u32 s15, s14, 8192
  s_mul_i32 s27, s26, 625
  s_add_u32 s52, s27, 625
  s_lshr_b32 s27, s27, 4
  s_lshr_b32 s52, s52, 4
  s_sub_u32 s52, s52, s27
  v_lshlrev_b32 v12, 4, v1
  v_lshlrev_b32 v104, 16, v0
  v_add_u32 v105, 16384, v104
  v_add_u32 v106, 32768, v104
  v_add_u32 v107, 49152, v104
  v_add_u32 v108, 2048, v0
  v_lshlrev_b32 v108, 14, v108
  s_waitcnt lgkmcnt(0)
  buffer_load_dwordx4 v[64:67], v2, s[68:71], s14 offen
  s_mov_b64 exec, s[88:89]
  buffer_load_dword v68, v3, s[68:71], s15 offen
  s_mov_b64 exec, -1
  buffer_load_dwordx4 v[72:75], v2, s[64:67], s14 offen
  s_mov_b64 exec, s[88:89]
  buffer_load_dword v76, v3, s[64:67], s15 offen
  s_mov_b64 exec, -1
  v_mov_b32 v20, -1
  v_mov_b32 v21, -1
  v_mov_b32 v22, -1
  v_mov_b32 v23, -1
  ds_write_b128 v2, v[20:23] offset:7168
  ds_write_b128 v2, v[20:23] offset:15360
  ds_write_b128 v2, v[20:23] offset:23552
  ds_write_b128 v2, v[20:23] offset:31744
  s_cmp_ge_u32 s3, 4
  s_cbranch_scc1 L_nohdr
  v_mul_u32_u24 v9, 132, v0
  ds_write_b128 v2, v[20:23] offset:39936
  v_add_u32 v9, 7168, v9
  ds_write_b32 v3, v9 offset:44032
L_nohdr:
  s_cmp_lg_u32 s3, 4
  s_cbranch_scc1 L_noinit
  v_mov_b32 v11, 0
  v_and_b32 v9, 1, v1
  ds_write_b32 v248, v11 offset:0
  v_lshlrev_b32 v9, 4, v9
  v_mov_b32 v10, 0x3f80
  v_lshlrev_b32 v10, v9, v10
  s_mov_b64 exec, 0xc03
  v_mov_b32 v11, v10
  s_mov_b32 exec_lo, -1
  ds_write_b32 v248, v11 offset:1280
  s_mov_b64 exec, -1
L_noinit:
  s_waitcnt lgkmcnt(0)
  s_load_dword s44, s[36:37], s100
  s_barrier
  s_cmp_eq_u32 s3, 3
  s_cselect_b32 s80, s16, s40
  s_cselect_b32 s81, s17, s41
  s_cselect_b32 s82, 128, s42
  s_mov_b32 s83, 0x20000
  s_cmp_lg_u32 s3, 7
  s_cbranch_scc1 L_nocw
  s_getpc_b64 s[92:93]
L_pc:
  s_mov_b32 s94, L_code_end-L_pc
  s_mov_b32 s95, 0x20000
  s_bfe_u32 s56, s2, 0x10003
  s_lshl_b32 s56, s56, 13
  v_lshlrev_b32 v9, 7, v1
  buffer_load_dword v252, v9, s[92:95], s56 offen
L_nocw:
  s_cmp_lg_u32 s3, 6
  s_cbranch_scc1 L_now0
  s_lshr_b32 s56, s2, 3
  s_mul_i32 s56, s56, 1920
  v_lshlrev_b32 v9, 7, v1
  s_mov_b64 exec, 0x7fff
  buffer_load_dword v252, v9, s[40:43], s56 offen
  s_mov_b64 exec, -1
L_now0:
  s_movk_i32 s56, 8192
  buffer_load_dwordx4 v[112:115], v2, s[72:75], s56 offen
  s_lshl_b32 s57, s3, 10
  s_add_u32 m0, s57, 64512
  v_mul_u32_u24 v18, 6, v1
  buffer_load_dwordx4 v2, s[72:75], 0 offen lds
  s_add_u32 m0, s57, 72704
  v_cmp_gt_u32 vcc, s52, v1
  buffer_load_dwordx4 v2, s[76:79], 0 offen lds
  s_add_u32 m0, s57, 89088
  s_nop 0
  buffer_load_dwordx4 v2, s[76:79], s56 offen lds
  s_add_u32 m0, s57, 80896
  s_lshl_b32 s56, s27, 7
  v_min_u32 v19, 0x17f0, v2
  buffer_load_dwordx4 v19, s[84:87], s56 offen lds
  v_mov_b32 v19, 0x7fffff00
  v_cndmask_b32 v18, v19, v18, vcc
  s_movk_i32 s58, 16384
  s_movk_i32 m0, 6528
  s_mov_b32 exec_hi, 0xff
  buffer_load_dwordx4 v12, s[72:75], s58 offen lds
  s_mov_b32 exec_hi, -1
  s_mul_i32 s56, s27, 6
  s_lshl_b32 s58, s3, 1
  s_add_u32 s56, s56, s58
  v_lshlrev_b32 v19, 1, v1
  s_cmp_eq_u32 s3, 3
  s_cselect_b32 s56, 0, s56
  s_cselect_b64 vcc, -1, 0
  v_cndmask_b32 v18, v18, v19, vcc
  buffer_load_ushort v140, v18, s[80:83], s56 offen
  v_and_b32 v10, 1, v1
  v_mul_u32_u24 v253, 12, v10
  v_lshrrev_b32 v9, 1, v0
  v_lshlrev_b32 v16, 2, v9
  v_mul_u32_u24 v15, 132, v9
  v_add_u32 v15, v15, v253
  v_add_u32 v15, 7264, v15
  s_mov_b32 s57, 41088
  s_mul_i32 s8, s26, s57
  s_lshl_b32 s56, s3, 10
  s_add_u32 s9, s8, s56
  s_add_u32 s9, s9, 32768
  s_lshl_b32 s56, s3, 12
  s_add_u32 s8, s8, s56
  s_movk_i32 s4, 625
  s_mov_b32 s5, 6871948
  s_movk_i32 s7, 7296
  v_lshlrev_b32 v199, 2, v10
  s_lshl_b32 s56, s3, 5
  v_lshrrev_b32 v9, 3, v1
  v_add_u32 v9, s56, v9
  v_and_b32 v10, 7, v1
  v_lshlrev_b32 v14, 2, v9
  v_mul_u32_u24 v24, 132, v9
  v_mad_u32_u24 v24, v10, 12, v24
  v_add_u32 v24, 7168, v24
  v_add_u32 v25, 1056, v24
  v_add_u32 v26, 2112, v24
  v_add_u32 v27, 3168, v24
  v_and_b32 v33, 3, v10
  v_mul_u32_u24 v33, 12, v33
  v_sub_u32 v32, v24, v33
  v_add_u32 v33, 1056, v32
  v_add_u32 v34, 2112, v32
  v_add_u32 v35, 3168, v32
  v_mul_u32_u24 v215, s57, v9
  v_lshl_add_u32 v215, v10, 4, v215
  s_movk_i32 s57, 2500
  v_mul_u32_u24 v249, s57, v9
  s_lshl_b32 s56, s26, 7
  v_add_u32 v215, s56, v215
  s_mov_b32 s28, s84
  s_or_b32 s29, s85, 0x800000
  s_or_b32 s33, s33, 0x80000
  s_mov_b32 s30, 10000
  s_mov_b32 s31, 0x20000
  s_mov_b32 s34, 640000
  s_mov_b32 s35, 0x20000
  s_mov_b32 s50, 1340000
  s_mov_b32 s51, 0x20000
  v_and_b32 v141, 31, v1
  v_lshrrev_b32 v142, 5, v1
  v_lshrrev_b32 v9, 4, v1
  v_bfe_u32 v10, v1, 2, 2
  v_and_b32 v11, 3, v1
  v_lshl_add_u32 v13, v142, 3, v10
  v_lshlrev_b32 v13, 7, v13
  v_lshl_add_u32 v13, v11, 3, v13
  v_and_b32 v18, 1, v9
  v_lshl_add_u32 v13, v18, 5, v13
  v_add_u32 v143, 56320, v13
  v_lshl_add_u32 v13, v9, 3, v10
  v_lshlrev_b32 v13, 7, v13
  v_lshl_add_u32 v13, v11, 4, v13
  s_and_b32 s56, s3, 1
  s_lshl_b32 s56, s56, 6
  s_add_u32 s57, s56, 56320
  v_add_u32 v255, s57, v13
  s_waitcnt vmcnt(9)
  v_lshl_or_b32 v80, v64, 4, 15
  v_lshl_or_b32 v81, v65, 4, 15
  v_lshl_or_b32 v82, v66, 4, 15
  v_lshl_or_b32 v83, v67, 4, 15
  v_lshl_or_b32 v84, v68, 4, 15
  v_mul_hi_u32 v80, v80, s5
  v_mul_hi_u32 v81, v81, s5
  v_mul_hi_u32 v82, v82, s5
  v_mul_hi_u32 v83, v83, s5
  v_mul_hi_u32 v84, v84, s5
  v_mul_u32_u24 v96, s4, v80
  v_lshlrev_b32 v80, 2, v80
  ds_add_rtn_u32 v88, v80, v8 offset:44032
  v_mul_u32_u24 v97, s4, v81
  v_lshlrev_b32 v81, 2, v81
  ds_add_rtn_u32 v89, v81, v8 offset:44032
  v_mul_u32_u24 v98, s4, v82
  v_lshlrev_b32 v82, 2, v82
  ds_add_rtn_u32 v90, v82, v8 offset:44032
  v_mul_u32_u24 v99, s4, v83
  v_lshlrev_b32 v83, 2, v83
  ds_add_rtn_u32 v91, v83, v8 offset:44032
  v_mul_u32_u24 v100, s4, v84
  v_lshlrev_b32 v84, 2, v84
  s_mov_b64 exec, s[88:89]
  ds_add_rtn_u32 v92, v84, v8 offset:44032
  s_mov_b64 exec, -1
  v_lshrrev_b32 v96, 4, v96
  v_sub_u32 v96, v64, v96
  v_lshl_or_b32 v96, v96, 26, v104
  v_mad_u32_u24 v80, v80, 33, s7
  v_lshrrev_b32 v97, 4, v97
  v_sub_u32 v97, v65, v97
  v_lshl_or_b32 v97, v97, 26, v105
  v_mad_u32_u24 v81, v81, 33, s7
  v_lshrrev_b32 v98, 4, v98
  v_sub_u32 v98, v66, v98
  v_lshl_or_b32 v98, v98, 26, v106
  v_mad_u32_u24 v82, v82, 33, s7
  v_lshrrev_b32 v99, 4, v99
  v_sub_u32 v99, v67, v99
  v_lshl_or_b32 v99, v99, 26, v107
  v_mad_u32_u24 v83, v83, 33, s7
  v_lshrrev_b32 v100, 4, v100
  v_sub_u32 v100, v68, v100
  v_lshl_or_b32 v100, v100, 26, v108
  v_mad_u32_u24 v84, v84, 33, s7
  s_waitcnt vmcnt(7)
  v_or_b32 v96, v96, v72
  v_or_b32 v97, v97, v73
  v_or_b32 v98, v98, v74
  v_or_b32 v99, v99, v75
  v_or_b32 v100, v100, v76
  s_waitcnt lgkmcnt(0)
  v_min_u32 v88, v80, v88
  ds_write_b32 v88, v96
  v_min_u32 v89, v81, v89
  ds_write_b32 v89, v97
  v_min_u32 v90, v82, v90
  ds_write_b32 v90, v98
  v_min_u32 v91, v83, v91
  ds_write_b32 v91, v99
  v_min_u32 v92, v84, v92
  s_mov_b64 exec, s[88:89]
  ds_write_b32 v92, v100
  s_mov_b64 exec, -1
  s_add_u32 s44, s44, 1
  v_mov_b32 v155, s44
  v_mov_b32 v159, s44
  v_mov_b32 v163, s44
  v_mov_b32 v167, s44
  v_mov_b32 v171, s44
  s_waitcnt lgkmcnt(0)
  s_barrier
  ds_read_b32 v28, v14 offset:44032
  ds_read2_b32 v[152:153], v24 offset0:0 offset1:1
  ds_read_b32 v154, v24 offset:8
  ds_read_b32 v29, v14 offset:44064
  ds_read2_b32 v[156:157], v25 offset0:0 offset1:1
  ds_read_b32 v158, v25 offset:8
  ds_read_b32 v30, v14 offset:44096
  ds_read2_b32 v[160:161], v26 offset0:0 offset1:1
  ds_read_b32 v162, v26 offset:8
  ds_read_b32 v31, v14 offset:44128
  ds_read2_b32 v[164:165], v27 offset0:0 offset1:1
  ds_read_b32 v166, v27 offset:8
  ds_read_b32 v17, v16 offset:44032
  s_waitcnt lgkmcnt(10)
  v_cmpx_ge_u32 vcc, v28, v24
  buffer_store_dwordx4 v[152:155], v12, s[36:39], s8 offen offset:0 sc1
  s_mov_b64 exec, -1
  s_waitcnt lgkmcnt(7)
  v_cmpx_ge_u32 vcc, v29, v25
  buffer_store_dwordx4 v[156:159], v12, s[36:39], s8 offen offset:1024 sc1
  s_mov_b64 exec, -1
  s_waitcnt lgkmcnt(4)
  v_cmpx_ge_u32 vcc, v30, v26
  buffer_store_dwordx4 v[160:163], v12, s[36:39], s8 offen offset:2048 sc1
  s_mov_b64 exec, -1
  s_waitcnt lgkmcnt(1)
  v_cmpx_ge_u32 vcc, v31, v27
  buffer_store_dwordx4 v[164:167], v12, s[36:39], s8 offen offset:3072 sc1
  s_mov_b64 exec, -1
  s_waitcnt lgkmcnt(0)
  v_cmp_ge_u32 vcc, v17, v15
  s_cbranch_vccnz L_store4
L_store4_back:
  s_mov_b32 s53, 0
  s_mov_b32 s55, 0
  s_mov_b32 s54, 8
  s_mov_b32 s60, 0
  s_mov_b32 s61, -1
  s_movk_i32 s59, 0xfc
  s_movk_i32 s94, 0x3fff
  s_mov_b32 s95, 0xfc000000
  s_mov_b32 s62, 0xbf800000
  s_mov_b32 s96, 97280
  s_and_b32 s63, s3, 3
  s_lshl_b32 s63, s63, 1
  s_lshr_b32 s56, s3, 2
  s_add_u32 s63, s63, s56
  s_and_b32 s101, s3, 3
  v_mov_b32 v212, 0x3f80
  v_mov_b32 v213, 0
  v_mov_b32 v251, 0x100
  s_mov_b64 exec, s[60:61]
  v_mov_b32 v212, 0
  v_mov_b32 v251, 0x200
  s_mov_b64 exec, -1
  v_lshlrev_b32 v208, 4, v142
  v_or_b32 v208, 1280, v208
  v_lshrrev_b32 v9, 2, v141
  v_mul_u32_u24 v209, 272, v9
  v_lshl_add_u32 v209, v142, 4, v209
  v_add_u32 v209, 97280, v209
  v_lshlrev_b32 v210, 3, v141
  v_lshl_add_u32 v210, v142, 2, v210
  v_add_u32 v210, 99456, v210
  v_lshrrev_b32 v9, 4, v1
  v_and_b32 v10, 7, v1
  v_xor_b32 v10, v9, v10
  v_lshlrev_b32 v201, 4, v10
  v_xor_b32 v203, 64, v201
  v_mov_b32 v205, v201
  v_mov_b32 v207, v203
  s_lshl_b32 s56, s3, 12
  s_add_u32 s56, s56, 56320
  v_lshrrev_b32 v10, 1, v141
  v_and_b32 v10, 7, v10
  v_xor_b32 v10, v10, v142
  v_lshlrev_b32 v10, 4, v10
  v_lshl_add_u32 v10, v141, 7, v10
  v_add_u32 v56, s56, v10
  v_xor_b32 v57, 32, v56
  v_xor_b32 v58, 64, v56
  v_xor_b32 v59, 96, v56
  v_lshrrev_b32 v211, 3, v1
  v_lshlrev_b32 v60, 4, v211
  v_add_u32 v60, 7168, v60
  v_bfe_u32 v211, v1, 2, 2
  v_lshrrev_b32 v214, 5, v1
  v_lshl_add_u32 v211, v214, 2, v211
  v_lshlrev_b32 v61, 4, v211
  v_add_u32 v61, 7168, v61
  v_bfe_u32 v211, v1, 4, 1
  v_and_b32 v214, 3, v1
  v_lshl_add_u32 v211, v211, 2, v214
  v_lshl_or_b32 v197, v211, 26, v61
  v_and_b32 v211, 31, v1
  v_lshlrev_b32 v62, 4, v211
  s_lshl_b32 s56, s3, 8
  s_add_u32 s56, s56, 157696
  v_lshl_add_u32 v63, v211, 3, s56
  v_add_u32 v214, 7172, v62
  v_cndmask_b32 v63, v63, v214, s[60:61]
  v_lshrrev_b32 v211, 1, v1
  v_lshlrev_b32 v250, 4, v211
  s_mov_b32 s18, s56
  v_mov_b32 v180, 0
  s_mov_b32 exec_lo, 0x80808080
  s_mov_b32 exec_hi, 0x80808080
  v_mov_b32 v180, 0x7f
  s_mov_b64 exec, -1
  s_lshl3_add_u32 s21, s3, 7
  s_lshl_b32 s16, s3, 12
  s_add_u32 s16, s16, 56320
  v_mov_b32 v182, s95
  v_mov_b32 v183, 0
  v_lshrrev_b32 v186, 2, v60
  v_lshrrev_b32 v187, 2, v250
  v_add_u32 v186, 5376, v186
  s_mov_b32 s22, 0x01010101
  s_mov_b32 s23, 0x01010101
  v_mov_b32 v188, v249
  v_add_u32 v189, 20000, v249
  v_add_u32 v190, 40000, v249
  v_add_u32 v191, 60000, v249
  s_lshr_b32 s56, s2, 3
  s_mul_i32 s56, s56, 313
  v_mul_u32_u24 v184, 157, v0
  v_lshrrev_b32 v184, 8, v184
  v_add_u32 v184, s56, v184
  s_mul_i32 s56, s26, 2500
  v_mul_u32_u24 v185, 5, v0
  v_add_u32 v185, s56, v185
  s_waitcnt vmcnt(10)
  s_mov_b32 s56, 0xbfb8aa3b
  s_mov_b32 s57, 0xffff0000
  v_lshlrev_b32 v144, 16, v112
  v_and_b32 v145, s57, v112
  v_lshlrev_b32 v146, 16, v113
  v_and_b32 v147, s57, v113
  v_lshlrev_b32 v148, 16, v114
  v_and_b32 v149, s57, v114
  v_lshlrev_b32 v150, 16, v115
  v_and_b32 v151, s57, v115
  v_mul_f32 v144, s56, v144
  v_mul_f32 v145, s56, v145
  v_mul_f32 v146, s56, v146
  v_mul_f32 v147, s56, v147
  v_mul_f32 v148, s56, v148
  v_mul_f32 v149, s56, v149
  v_mul_f32 v150, s56, v150
  v_mul_f32 v151, s56, v151
  v_cvt_pk_bf16_f32 v112, v144, v145
  v_cvt_pk_bf16_f32 v113, v146, v147
  v_cvt_pk_bf16_f32 v114, v148, v149
  v_cvt_pk_bf16_f32 v115, v150, v151
  v_add_u32 v9, 56320, v2
  ds_write_b128 v9, v[112:115]
  s_cmp_eq_u32 s3, 3
  s_cselect_b32 s56, 0xbf317218, 1.0
  s_lshl_b32 s58, s3, 8
  v_add_u32 v9, s58, v248
  s_waitcnt vmcnt(4)
  v_lshlrev_b32 v140, 16, v140
  v_mul_f32 v140, s56, v140
  s_cmp_ge_u32 s3, 4
  s_cbranch_scc1 L_nopd
  ds_write_b32 v9, v140 offset:256
L_nopd:
  s_and_b32 s56, s3, 1
  s_lshl_b32 s56, s56, 6
  v_add_u32 v13, s56, v143
  s_waitcnt lgkmcnt(0)
  s_barrier
  v_mov_b32 v253, v12
  s_lshl_b32 s45, s3, 10
  s_add_u32 s13, s45, 0
  s_add_u32 m0, s13, 97280
  s_nop 0
  buffer_load_dwordx4 v253, s[40:43], s13 offen lds
  s_add_u32 s13, s45, 8192
  s_add_u32 m0, s13, 97280
  s_nop 0
  buffer_load_dwordx4 v253, s[40:43], s13 offen lds
  s_add_u32 s13, s45, 16384
  s_add_u32 m0, s13, 97280
  s_nop 0
  buffer_load_dwordx4 v253, s[40:43], s13 offen lds
  s_add_u32 s13, s45, 24576
  s_add_u32 m0, s13, 97280
  s_nop 0
  buffer_load_dwordx4 v253, s[40:43], s13 offen lds
  s_cmp_lt_u32 s3, 4
  s_cbranch_scc1 L_noag
  v_lshlrev_b32 v9, 7, v141
  v_lshl_add_u32 v9, v142, 4, v9
  s_bfe_u32 s57, s3, 0x10001
  s_lshl_b32 s57, s57, 12
  s_add_u32 s57, s57, 80896
  v_add_u32 v9, s57, v9
  ds_read_b128 v[112:115], v9 offset:0
  ds_read_b64_tr_b16 v[64:65], v13 offset:8192
  ds_read_b64_tr_b16 v[66:67], v13 offset:8704
  ds_read_b128 v[116:119], v9 offset:32
  ds_read_b64_tr_b16 v[68:69], v13 offset:10240
  ds_read_b64_tr_b16 v[70:71], v13 offset:10752
  ds_read_b128 v[120:123], v9 offset:64
  ds_read_b64_tr_b16 v[72:73], v13 offset:12288
  ds_read_b64_tr_b16 v[74:75], v13 offset:12800
  ds_read_b128 v[124:127], v9 offset:96
  ds_read_b64_tr_b16 v[76:77], v13 offset:14336
  ds_read_b64_tr_b16 v[78:79], v13 offset:14848
  s_waitcnt lgkmcnt(9)
  v_mfma_f32_32x32x16_bf16 v[80:95], v[112:115], v[64:67], 0
  s_waitcnt lgkmcnt(6)
  v_mfma_f32_32x32x16_bf16 v[80:95], v[116:119], v[68:71], v[80:95]
  s_waitcnt lgkmcnt(3)
  v_mfma_f32_32x32x16_bf16 v[80:95], v[120:123], v[72:75], v[80:95]
  s_waitcnt lgkmcnt(0)
  v_mfma_f32_32x32x16_bf16 v[80:95], v[124:127], v[76:79], v[80:95]
L_noag:
  s_cmp_ge_u32 s3, 6
  s_cbranch_scc1 L_nouh
  v_and_b32 v10, 15, v1
  v_lshlrev_b32 v10, 7, v10
  v_lshrrev_b32 v11, 4, v1
  v_lshl_add_u32 v10, v11, 4, v10
  s_lshr_b32 s57, s3, 1
  s_lshl_b32 s57, s57, 11
  s_add_u32 s57, s57, 80896
  v_add_u32 v10, s57, v10
  ds_read_b128 v[128:131], v10 offset:0
  ds_read_b128 v[132:135], v10 offset:64
  ds_read_b64_tr_b16 v[96:97], v255 offset:16384
  ds_read_b64_tr_b16 v[98:99], v255 offset:16896
  ds_read_b64_tr_b16 v[100:101], v255 offset:20480
  ds_read_b64_tr_b16 v[102:103], v255 offset:20992
  ds_read_b64_tr_b16 v[104:105], v255 offset:16392
  ds_read_b64_tr_b16 v[106:107], v255 offset:16904
  ds_read_b64_tr_b16 v[108:109], v255 offset:20488
  ds_read_b64_tr_b16 v[110:111], v255 offset:21000
  s_waitcnt lgkmcnt(0)
  v_mfma_f32_16x16x32_bf16 v[44:47], v[96:99], v[128:131], 0
  v_mfma_f32_16x16x32_bf16 v[48:51], v[104:107], v[128:131], 0
  v_mfma_f32_16x16x32_bf16 v[44:47], v[100:103], v[132:135], v[44:47]
  v_mfma_f32_16x16x32_bf16 v[48:51], v[108:111], v[132:135], v[48:51]
  s_bitcmp1_b32 s3, 0
  s_cselect_b64 vcc, -1, 0
  v_cndmask_b32 v52, v128, v132, vcc
  v_cndmask_b32 v53, v129, v133, vcc
  v_cndmask_b32 v54, v130, v134, vcc
  v_cndmask_b32 v55, v131, v135, vcc
L_nouh:
  v_mul_u32_u24 v9, 1152, v142
  v_sub_u32 v9, v143, v9
  v_lshlrev_b32 v10, 4, v142
  v_add_u32 v9, 4294917632, v9
  ds_read_b64_tr_b16 v[136:137], v9
  ds_read_b64_tr_b16 v[138:139], v9 offset:64
  ds_read_b128 v[216:219], v10 offset:1024
  ds_read_b128 v[220:223], v10 offset:1056
  ds_read_b128 v[224:227], v10 offset:1088
  ds_read_b128 v[228:231], v10 offset:1120
  ds_read_b128 v[232:235], v10 offset:1152
  ds_read_b128 v[236:239], v10 offset:1184
  ds_read_b128 v[240:243], v10 offset:1216
  ds_read_b128 v[244:247], v10 offset:1248
  s_mov_b32 s57, 0xbfb8aa3b
  s_mov_b32 s56, 0xffff0000
  s_waitcnt lgkmcnt(8)
  v_lshlrev_b32 v144, 16, v136
  v_and_b32 v145, s56, v136
  v_lshlrev_b32 v146, 16, v137
  v_and_b32 v147, s56, v137
  v_lshlrev_b32 v148, 16, v138
  v_and_b32 v149, s56, v138
  v_lshlrev_b32 v150, 16, v139
  v_and_b32 v151, s56, v139
  ds_read_b64_tr_b16 v[4:5], v143 offset:0
  ds_read_b64_tr_b16 v[6:7], v143 offset:512
  ds_read_b64_tr_b16 v[8:9], v143 offset:2048
  ds_read_b64_tr_b16 v[10:11], v143 offset:2560
  ds_read_b64_tr_b16 v[12:13], v143 offset:4096
  ds_read_b64_tr_b16 v[14:15], v143 offset:4608
  ds_read_b64_tr_b16 v[16:17], v143 offset:6144
  ds_read_b64_tr_b16 v[18:19], v143 offset:6656
  ds_read_b64_tr_b16 v[20:21], v143 offset:64
  ds_read_b64_tr_b16 v[22:23], v143 offset:576
  ds_read_b64_tr_b16 v[24:25], v143 offset:2112
  ds_read_b64_tr_b16 v[26:27], v143 offset:2624
  ds_read_b64_tr_b16 v[28:29], v143 offset:4160
  ds_read_b64_tr_b16 v[30:31], v143 offset:4672
  ds_read_b64_tr_b16 v[32:33], v143 offset:6208
  ds_read_b64_tr_b16 v[34:35], v143 offset:6720
  buffer_load_dwordx4 v[156:159], v215, s[36:39], 0 offen sc1
  s_mov_b32 s56, 328704
  buffer_load_dwordx4 v[160:163], v215, s[36:39], s56 offen sc1
  s_mov_b32 s56, 657408
  buffer_load_dwordx4 v[164:167], v215, s[36:39], s56 offen sc1
  s_mov_b32 s56, 986112
  buffer_load_dwordx4 v[168:171], v215, s[36:39], s56 offen sc1
  v_mul_f32 v144, s57, v144
  v_mul_f32 v145, s57, v145
  v_mul_f32 v146, s57, v146
  v_mul_f32 v147, s57, v147
  v_mul_f32 v148, s57, v148
  v_mul_f32 v149, s57, v149
  v_mul_f32 v150, s57, v150
  v_mul_f32 v151, s57, v151
  v_cvt_pk_bf16_f32 v38, v144, v145
  v_cvt_pk_bf16_f32 v39, v146, v147
  v_cvt_pk_bf16_f32 v42, v148, v149
  v_cvt_pk_bf16_f32 v43, v150, v151
  s_mov_b64 exec, s[60:61]
  v_cvt_pk_bf16_f32 v38, 0, v144
  v_cvt_pk_bf16_f32 v42, 0, v148
  v_sub_f32 v144, v144, v38
  v_sub_f32 v148, v148, v42
  v_cvt_pk_bf16_f32 v39, 0, v144
  v_cvt_pk_bf16_f32 v43, 0, v148
  s_mov_b64 exec, -1
  s_cmp_lt_u32 s3, 4
  s_cbranch_scc1 L_noag2
  s_and_b32 s56, s3, 1
  s_lshl_b32 s56, s56, 9
  s_bfe_u32 s58, s3, 0x10001
  s_lshl_b32 s58, s58, 12
  s_add_u32 s56, s56, s58
  v_lshl_add_u32 v3, v1, 3, s56
  v_mul_f32 v80, s57, v80
  v_mul_f32 v81, s57, v81
  v_mul_f32 v82, s57, v82
  v_mul_f32 v83, s57, v83
  v_mul_f32 v84, s57, v84
  v_mul_f32 v85, s57, v85
  v_mul_f32 v86, s57, v86
  v_mul_f32 v87, s57, v87
  v_mul_f32 v88, s57, v88
  v_mul_f32 v89, s57, v89
  v_mul_f32 v90, s57, v90
  v_mul_f32 v91, s57, v91
  v_mul_f32 v92, s57, v92
  v_mul_f32 v93, s57, v93
  v_mul_f32 v94, s57, v94
  v_mul_f32 v95, s57, v95
  v_cvt_pk_bf16_f32 v80, v80, v81
  v_cvt_pk_bf16_f32 v81, v82, v83
  v_cvt_pk_bf16_f32 v82, v84, v85
  v_cvt_pk_bf16_f32 v83, v86, v87
  v_cvt_pk_bf16_f32 v84, v88, v89
  v_cvt_pk_bf16_f32 v85, v90, v91
  v_cvt_pk_bf16_f32 v86, v92, v93
  v_cvt_pk_bf16_f32 v87, v94, v95
  ds_write_b64 v3, v[80:81] offset:1408
  s_bitcmp1_b32 s3, 1
  s_cbranch_scc1 L_noag2
  ds_write_b64 v3, v[82:83] offset:2432
  ds_write_b64 v3, v[84:85] offset:3456
  ds_write_b64 v3, v[86:87] offset:4480
L_noag2:
  v_mov_b32 v64, 0
  v_mov_b32 v65, 0
  v_mov_b32 v66, 0
  v_mov_b32 v67, 0
  v_mov_b32 v68, 0
  v_mov_b32 v69, 0
  v_mov_b32 v70, 0
  v_mov_b32 v71, 0
  v_mov_b32 v72, 0
  v_mov_b32 v73, 0
  v_mov_b32 v74, 0
  v_mov_b32 v75, 0
  v_mov_b32 v76, 0
  v_mov_b32 v77, 0
  v_mov_b32 v78, 0
  v_mov_b32 v79, 0
  v_mov_b32 v80, 0
  v_mov_b32 v81, 0
  v_mov_b32 v82, 0
  v_mov_b32 v83, 0
  v_mov_b32 v84, 0
  v_mov_b32 v85, 0
  v_mov_b32 v86, 0
  v_mov_b32 v87, 0
  v_mov_b32 v88, 0
  v_mov_b32 v89, 0
  v_mov_b32 v90, 0
  v_mov_b32 v91, 0
  v_mov_b32 v92, 0
  v_mov_b32 v93, 0
  v_mov_b32 v94, 0
  v_mov_b32 v95, 0
  v_mov_b32 v2, 4
  s_mov_b32 s47, 0
L_chk:
  s_waitcnt vmcnt(3)
  v_cmpx_eq_u32 s[4:5], s44, v159
  v_cmpx_gt_u32 s[64:65], s95, v156
  v_cmpx_gt_u32 s[66:67], s95, v157
  v_cmpx_gt_u32 s[68:69], s95, v158
  s_mov_b64 exec, -1
  v_and_b32_sdwa v124, v156, s59 dst_sel:DWORD dst_unused:UNUSED_PAD src0_sel:BYTE_3 src1_sel:DWORD
  v_and_b32_sdwa v125, v157, s59 dst_sel:DWORD dst_unused:UNUSED_PAD src0_sel:BYTE_3 src1_sel:DWORD
  v_and_b32_sdwa v126, v158, s59 dst_sel:DWORD dst_unused:UNUSED_PAD src0_sel:BYTE_3 src1_sel:DWORD
  s_lshl_b64 s[12:13], s[68:69], 1
  s_or_b64 s[12:13], s[12:13], s[22:23]
  s_andn2_b64 s[4:5], s[12:13], s[4:5]
  s_waitcnt vmcnt(2)
  v_cmpx_eq_u32 s[6:7], s44, v163
  v_cmpx_gt_u32 s[70:71], s95, v160
  v_cmpx_gt_u32 s[72:73], s95, v161
  v_cmpx_gt_u32 s[74:75], s95, v162
  s_mov_b64 exec, -1
  v_and_b32_sdwa v127, v160, s59 dst_sel:DWORD dst_unused:UNUSED_PAD src0_sel:BYTE_3 src1_sel:DWORD
  v_and_b32_sdwa v128, v161, s59 dst_sel:DWORD dst_unused:UNUSED_PAD src0_sel:BYTE_3 src1_sel:DWORD
  v_and_b32_sdwa v129, v162, s59 dst_sel:DWORD dst_unused:UNUSED_PAD src0_sel:BYTE_3 src1_sel:DWORD
  s_lshl_b64 s[12:13], s[74:75], 1
  s_or_b64 s[12:13], s[12:13], s[22:23]
  s_andn2_b64 s[6:7], s[12:13], s[6:7]
  s_or_b64 s[14:15], s[4:5], s[6:7]
  s_waitcnt vmcnt(1)
  v_cmpx_eq_u32 s[8:9], s44, v167
  v_cmpx_gt_u32 s[76:77], s95, v164
  v_cmpx_gt_u32 s[78:79], s95, v165
  v_cmpx_gt_u32 s[80:81], s95, v166
  s_mov_b64 exec, -1
  v_and_b32_sdwa v130, v164, s59 dst_sel:DWORD dst_unused:UNUSED_PAD src0_sel:BYTE_3 src1_sel:DWORD
  v_and_b32_sdwa v131, v165, s59 dst_sel:DWORD dst_unused:UNUSED_PAD src0_sel:BYTE_3 src1_sel:DWORD
  v_and_b32_sdwa v132, v166, s59 dst_sel:DWORD dst_unused:UNUSED_PAD src0_sel:BYTE_3 src1_sel:DWORD
  s_lshl_b64 s[12:13], s[80:81], 1
  s_or_b64 s[12:13], s[12:13], s[22:23]
  s_andn2_b64 s[8:9], s[12:13], s[8:9]
  s_or_b64 s[14:15], s[14:15], s[8:9]
  s_waitcnt vmcnt(0)
  v_cmpx_eq_u32 s[10:11], s44, v171
  v_cmpx_gt_u32 s[82:83], s95, v168
  v_cmpx_gt_u32 s[84:85], s95, v169
  v_cmpx_gt_u32 s[86:87], s95, v170
  s_mov_b64 exec, -1
  v_and_b32_sdwa v133, v168, s59 dst_sel:DWORD dst_unused:UNUSED_PAD src0_sel:BYTE_3 src1_sel:DWORD
  v_and_b32_sdwa v134, v169, s59 dst_sel:DWORD dst_unused:UNUSED_PAD src0_sel:BYTE_3 src1_sel:DWORD
  v_and_b32_sdwa v135, v170, s59 dst_sel:DWORD dst_unused:UNUSED_PAD src0_sel:BYTE_3 src1_sel:DWORD
  s_lshl_b64 s[12:13], s[86:87], 1
  s_or_b64 s[12:13], s[12:13], s[22:23]
  s_andn2_b64 s[10:11], s[12:13], s[10:11]
  s_or_b64 s[14:15], s[14:15], s[10:11]
  s_cbranch_scc1 L_miss
L_arrived:
  s_or_b64 s[12:13], s[68:69], s[74:75]
  s_or_b64 s[14:15], s[80:81], s[86:87]
  s_or_b64 s[12:13], s[12:13], s[14:15]
  s_or_b32 s12, s12, s13
  s_mov_b32 s46, 0
  s_and_b32 s12, s12, 0x80808080
  s_cbranch_scc1 L_ext
L_hj:
  s_cmp_lt_u32 s54, 8
  s_cbranch_scc1 L_gate
  s_mov_b64 exec, s[64:65]
  ds_add_rtn_u32 v139, v124, v2 offset:0
  s_mov_b64 exec, s[66:67]
  ds_add_rtn_u32 v140, v125, v2 offset:0
  s_mov_b64 exec, s[68:69]
  ds_add_rtn_u32 v141, v126, v2 offset:0
  s_mov_b64 exec, s[70:71]
  ds_add_rtn_u32 v142, v127, v2 offset:0
  s_mov_b64 exec, s[72:73]
  ds_add_rtn_u32 v143, v128, v2 offset:0
  s_mov_b64 exec, s[74:75]
  ds_add_rtn_u32 v144, v129, v2 offset:0
  s_mov_b64 exec, s[76:77]
  ds_add_rtn_u32 v145, v130, v2 offset:0
  s_mov_b64 exec, s[78:79]
  ds_add_rtn_u32 v146, v131, v2 offset:0
  s_mov_b64 exec, s[80:81]
  ds_add_rtn_u32 v147, v132, v2 offset:0
  s_mov_b64 exec, s[82:83]
  ds_add_rtn_u32 v148, v133, v2 offset:0
  s_mov_b64 exec, s[84:85]
  ds_add_rtn_u32 v149, v134, v2 offset:0
  s_mov_b64 exec, s[86:87]
  ds_add_rtn_u32 v150, v135, v2 offset:0
  s_mov_b64 exec, -1
  s_add_u32 s13, s45, 32768
  s_add_u32 m0, s13, 97280
  s_nop 0
  buffer_load_dwordx4 v253, s[40:43], s13 offen lds
  s_add_u32 s13, s45, 40960
  s_add_u32 m0, s13, 97280
  s_nop 0
  buffer_load_dwordx4 v253, s[40:43], s13 offen lds
  s_add_u32 s13, s45, 49152
  s_add_u32 m0, s13, 97280
  s_nop 0
  buffer_load_dwordx4 v253, s[40:43], s13 offen lds
  s_add_u32 s13, s45, 57344
  s_min_u32 s13, s13, 59392
  s_add_u32 m0, s13, 97280
  s_nop 0
  buffer_load_dwordx4 v253, s[40:43], s13 offen lds
L_cnt_done:
  s_cmp_lg_u32 s46, 0
  s_cbranch_scc1 L_extA
L_extA_back:
  s_waitcnt lgkmcnt(0)
  s_barrier
  ds_read_b32 v176, v248 offset:0
  ds_read_b32 v178, v248 offset:1344
  buffer_load_dword v252, v184, s[28:31], 0 idxen
  s_waitcnt lgkmcnt(1)
  v_add_u32_dpp v177, v176, v176 quad_perm:[1,0,3,2] row_mask:0xf bank_mask:0xf
  s_nop 1
  v_add_u32_dpp v177, v177, v177 quad_perm:[2,3,0,1] row_mask:0xf bank_mask:0xf
  s_nop 1
  v_add_u32_dpp v177, v177, v177 row_half_mirror row_mask:0xf bank_mask:0xf
  v_sub_u32 v179, 0, v177
  v_and_b32 v179, v180, v179
  v_add_u32 v176, v176, v179
  v_mov_b32 v0, v176
  s_nop 1
  v_add_u32_dpp v0, v0, v0 row_shr:1 row_mask:0xf bank_mask:0xf
  s_nop 1
  v_add_u32_dpp v0, v0, v0 row_shr:2 row_mask:0xf bank_mask:0xf
  s_nop 1
  v_add_u32_dpp v0, v0, v0 row_shr:4 row_mask:0xf bank_mask:0xf
  s_nop 1
  v_add_u32_dpp v0, v0, v0 row_shr:8 row_mask:0xf bank_mask:0xf
  s_nop 1
  v_add_u32_dpp v0, v0, v0 row_bcast:15 row_mask:0xa bank_mask:0xf
  s_nop 1
  v_add_u32_dpp v0, v0, v0 row_bcast:31 row_mask:0xc bank_mask:0xf
  v_sub_u32 v176, v0, v176
  ds_bpermute_b32 v124, v124, v176
  ds_bpermute_b32 v125, v125, v176
  ds_bpermute_b32 v126, v126, v176
  ds_bpermute_b32 v127, v127, v176
  ds_bpermute_b32 v128, v128, v176
  ds_bpermute_b32 v129, v129, v176
  ds_bpermute_b32 v130, v130, v176
  ds_bpermute_b32 v131, v131, v176
  ds_bpermute_b32 v132, v132, v176
  ds_bpermute_b32 v133, v133, v176
  ds_bpermute_b32 v134, v134, v176
  ds_bpermute_b32 v135, v135, v176
  v_readlane_b32 s20, v0, 39
  v_readlane_b32 s56, v179, s21
  v_readlane_b32 s57, v0, s21
  s_waitcnt lgkmcnt(12)
  v_cmp_ne_u32 vcc, 0, v178
  s_lshr_b32 s4, s20, 7
  s_sub_u32 s57, s57, s56
  s_and_b32 s19, vcc_lo, 0xff
  v_cmp_gt_u32 s[6:7], s56, v248
  v_add_u32 v181, s57, v248
  s_cmp_gt_u32 s20, 11776
  s_cselect_b32 s56, 1, s19
  s_or_b32 s57, s2, s53
  s_cbranch_scc0 L_bump
L_bump_back:
  s_cmp_eq_u32 s53, 0
  s_cselect_b32 s56, s56, 0
  s_cmp_lg_u32 s56, 0
  s_cbranch_scc1 L_goslow
L_goslow_back:
  s_mul_i32 s57, s101, s4
  s_add_u32 s58, s57, s4
  s_lshr_b32 s57, s57, 2
  s_lshr_b32 s58, s58, 2
  s_add_u32 s56, s57, s58
  s_add_u32 s56, s56, 2
  s_lshr_b32 s56, s56, 1
  s_min_u32 s56, s56, s58
  s_cmp_lt_u32 s3, 4
  s_cselect_b32 s10, s57, s56
  s_cselect_b32 s11, s56, s58
  s_lshl_b32 s5, s10, 9
  s_lshl_b32 s9, s10, 7
  v_add_u32 v186, s9, v186
  v_add_u32 v187, s9, v187
  v_add_u32 v178, s9, v248
  s_waitcnt lgkmcnt(0)
  s_mov_b64 exec, s[64:65]
  v_add_u32 v124, v124, v139
  ds_write2st64_b32 v124, v156, v188 offset0:28 offset1:76
  s_mov_b64 exec, s[66:67]
  v_add_u32 v125, v125, v140
  ds_write2st64_b32 v125, v157, v188 offset0:28 offset1:76
  s_mov_b64 exec, s[68:69]
  v_add_u32 v126, v126, v141
  ds_write2st64_b32 v126, v158, v188 offset0:28 offset1:76
  s_mov_b64 exec, s[70:71]
  v_add_u32 v127, v127, v142
  ds_write2st64_b32 v127, v160, v189 offset0:28 offset1:76
  s_mov_b64 exec, s[72:73]
  v_add_u32 v128, v128, v143
  ds_write2st64_b32 v128, v161, v189 offset0:28 offset1:76
  s_mov_b64 exec, s[74:75]
  v_add_u32 v129, v129, v144
  ds_write2st64_b32 v129, v162, v189 offset0:28 offset1:76
  s_mov_b64 exec, s[76:77]
  v_add_u32 v130, v130, v145
  ds_write2st64_b32 v130, v164, v190 offset0:28 offset1:76
  s_mov_b64 exec, s[78:79]
  v_add_u32 v131, v131, v146
  ds_write2st64_b32 v131, v165, v190 offset0:28 offset1:76
  s_mov_b64 exec, s[80:81]
  v_add_u32 v132, v132, v147
  ds_write2st64_b32 v132, v166, v190 offset0:28 offset1:76
  s_mov_b64 exec, s[82:83]
  v_add_u32 v133, v133, v148
  ds_write2st64_b32 v133, v168, v191 offset0:28 offset1:76
  s_mov_b64 exec, s[84:85]
  v_add_u32 v134, v134, v149
  ds_write2st64_b32 v134, v169, v191 offset0:28 offset1:76
  s_mov_b64 exec, s[86:87]
  v_add_u32 v135, v135, v150
  ds_write2st64_b32 v135, v170, v191 offset0:28 offset1:76
  s_mov_b64 exec, s[6:7]
  ds_write2st64_b32 v181, v182, v183 offset0:28 offset1:76
  s_mov_b64 exec, -1
  s_cmp_lg_u32 s46, 0
  s_cbranch_scc1 L_extB
L_extB_back:
  s_sub_u32 s64, s28, 1024
  s_subb_u32 s65, s29, 0
  s_mov_b32 s66, 10000
  s_mov_b32 s67, 0x20000
  s_sub_u32 s68, s28, 2048
  s_subb_u32 s69, s29, 0
  s_mov_b32 s70, 10000
  s_mov_b32 s71, 0x20000
  s_sub_u32 s72, s28, 3072
  s_subb_u32 s73, s29, 0
  s_mov_b32 s74, 10000
  s_mov_b32 s75, 0x20000
  s_setprio 3
  s_cmp_ge_u32 s10, s11
  s_waitcnt vmcnt(1) lgkmcnt(0)
  s_barrier
  s_cbranch_scc1 L_empty
  ds_read2_b32 v[188:189], v186 offset0:0 offset1:8
  ds_read2_b32 v[190:191], v186 offset0:16 offset1:24
  ds_read2st64_b32 v[164:165], v187 offset0:28 offset1:76
  ds_read2st64_b32 v[168:169], v187 offset0:29 offset1:77
  v_add_u32 v187, 128, v187
  ds_read2st64_b32 v[166:167], v187 offset0:28 offset1:76
  ds_read2st64_b32 v[96:97], v178 offset0:28 offset1:76
  ds_read2st64_b32 v[100:101], v178 offset0:29 offset1:77
  ds_read2st64_b32 v[104:105], v178 offset0:30 offset1:78
  ds_read2st64_b32 v[108:109], v178 offset0:31 offset1:79
  ds_read2st64_b32 v[112:113], v178 offset0:32 offset1:80
  ds_read2st64_b32 v[116:117], v178 offset0:33 offset1:81
  v_add_u32 v60, s5, v60
  v_add_u32 v250, s5, v250
  v_add_u32 v62, s5, v62
  v_lshl_add_u32 v2, v1, 4, s5
  v_cmp_ge_u32 vcc, s9, v0
  s_and_b32 s56, vcc_lo, 0x80808080
  s_bcnt1_i32_b32 s12, s56
  s_lshl3_add_u32 s56, s12, 7
  v_readlane_b32 s15, v0, s56
  s_lshl_b32 s56, s12, 10
  v_lshl_add_u32 v211, v1, 3, s56
  s_lshr_b32 s15, s15, 7
  ds_read_b64 v[36:37], v211 offset:1408
  ds_read_b64 v[40:41], v211 offset:1920
  v_mov_b32 v193, v199
  v_mov_b32 v195, v199
  v_mov_b32 v3, 0xbf80
  s_waitcnt lgkmcnt(8)
  v_bfe_u32 v164, v164, 14, 12
  v_bfe_u32 v166, v166, 14, 12
  v_bfe_u32 v168, v168, 14, 12
  v_add_u32 v198, v164, v165
  v_add_u32 v192, v166, v167
  v_add_u32 v194, v168, v169
  s_cmp_lt_u32 s3, 4
  s_cbranch_scc0 L_d1
  s_add_u32 m0, s16, 0
  v_and_b32 v200, s94, v188
  buffer_load_dwordx4 v[200:201], s[28:31], 0 idxen offen lds
  v_and_b32 v202, s94, v189
  buffer_load_dwordx4 v[202:203], s[64:67], 0 idxen offen offset:1024 lds
  v_and_b32 v204, s94, v190
  buffer_load_dwordx4 v[204:205], s[68:71], 0 idxen offen offset:2048 lds
  v_and_b32 v206, s94, v191
  buffer_load_dwordx4 v[206:207], s[72:75], 0 idxen offen offset:3072 lds
  s_mov_b32 m0, s18
  s_add_u32 s18, s18, 256
  buffer_load_dword v[198:199], s[32:35], 0 idxen offen lds
L_d1:
  s_waitcnt lgkmcnt(7)
  v_and_b32 v158, s94, v96
  v_and_b32_sdwa v152, v96, s59 dst_sel:DWORD dst_unused:UNUSED_PAD src0_sel:BYTE_3 src1_sel:DWORD
  v_mad_u32_u24 v132, v158, 6, s96
  v_lshlrev_b32 v138, 3, v132
  v_and_b32 v132, -4, v132
  ds_read2_b32 v[98:99], v132 offset0:0 offset1:1
  ds_read2st64_b32 v[120:121], v152 offset0:1 offset1:2
  ds_read_b32 v132, v152 offset:768
  s_waitcnt lgkmcnt(9)
  v_and_b32 v159, s94, v100
  v_and_b32_sdwa v153, v100, s59 dst_sel:DWORD dst_unused:UNUSED_PAD src0_sel:BYTE_3 src1_sel:DWORD
  v_mad_u32_u24 v133, v159, 6, s96
  v_lshlrev_b32 v139, 3, v133
  v_and_b32 v133, -4, v133
  ds_read2_b32 v[102:103], v133 offset0:0 offset1:1
  ds_read2st64_b32 v[122:123], v153 offset0:1 offset1:2
  ds_read_b32 v133, v153 offset:768
  s_waitcnt lgkmcnt(11)
  v_and_b32 v160, s94, v104
  v_and_b32_sdwa v154, v104, s59 dst_sel:DWORD dst_unused:UNUSED_PAD src0_sel:BYTE_3 src1_sel:DWORD
  v_mad_u32_u24 v134, v160, 6, s96
  v_lshlrev_b32 v140, 3, v134
  v_and_b32 v134, -4, v134
  ds_read2_b32 v[106:107], v134 offset0:0 offset1:1
  ds_read2st64_b32 v[124:125], v154 offset0:1 offset1:2
  ds_read_b32 v134, v154 offset:768
  v_bfe_u32 v152, v96, 14, 12
  v_bfe_u32 v153, v100, 14, 12
  v_bfe_u32 v154, v104, 14, 12
  v_add_u32 v97, v97, v152
  v_lshlrev_b32 v152, v138, v3
  v_add_u32 v101, v101, v153
  v_lshlrev_b32 v153, v139, v3
  v_add_u32 v105, v105, v154
  v_lshlrev_b32 v154, v140, v3
  v_and_or_b32 v96, v96, s95, v97
  v_and_or_b32 v100, v100, s95, v101
  v_and_or_b32 v104, v104, s95, v105
  s_waitcnt lgkmcnt(13)
  v_and_b32 v161, s94, v108
  v_and_b32_sdwa v155, v108, s59 dst_sel:DWORD dst_unused:UNUSED_PAD src0_sel:BYTE_3 src1_sel:DWORD
  v_mad_u32_u24 v135, v161, 6, s96
  v_lshlrev_b32 v141, 3, v135
  v_and_b32 v135, -4, v135
  ds_read2_b32 v[110:111], v135 offset0:0 offset1:1
  ds_read2st64_b32 v[126:127], v155 offset0:1 offset1:2
  ds_read_b32 v135, v155 offset:768
  s_waitcnt lgkmcnt(15)
  v_and_b32 v162, s94, v112
  v_and_b32_sdwa v156, v112, s59 dst_sel:DWORD dst_unused:UNUSED_PAD src0_sel:BYTE_3 src1_sel:DWORD
  v_mad_u32_u24 v136, v162, 6, s96
  v_lshlrev_b32 v142, 3, v136
  v_and_b32 v136, -4, v136
  ds_read2_b32 v[114:115], v136 offset0:0 offset1:1
  ds_read2st64_b32 v[128:129], v156 offset0:1 offset1:2
  ds_read_b32 v136, v156 offset:768
  s_waitcnt lgkmcnt(15)
  v_and_b32 v163, s94, v116
  v_and_b32_sdwa v157, v116, s59 dst_sel:DWORD dst_unused:UNUSED_PAD src0_sel:BYTE_3 src1_sel:DWORD
  v_mad_u32_u24 v137, v163, 6, s96
  v_lshlrev_b32 v143, 3, v137
  v_and_b32 v137, -4, v137
  ds_read2_b32 v[118:119], v137 offset0:0 offset1:1
  ds_read2st64_b32 v[130:131], v157 offset0:1 offset1:2
  ds_read_b32 v137, v157 offset:768
  v_bfe_u32 v155, v108, 14, 12
  v_bfe_u32 v156, v112, 14, 12
  v_bfe_u32 v157, v116, 14, 12
  v_add_u32 v109, v109, v155
  v_lshlrev_b32 v155, v141, v3
  v_add_u32 v113, v113, v156
  v_lshlrev_b32 v156, v142, v3
  v_add_u32 v117, v117, v157
  v_lshlrev_b32 v157, v143, v3
  v_and_or_b32 v108, v108, s95, v109
  v_and_or_b32 v112, v112, s95, v113
  v_and_or_b32 v116, v116, s95, v117
  s_waitcnt lgkmcnt(0)
  s_barrier
  s_cmp_lt_u32 s3, 4
  s_cbranch_scc1 L_d2
  s_add_u32 m0, s16, 0
  v_and_b32 v200, s94, v188
  buffer_load_dwordx4 v[200:201], s[28:31], 0 idxen offen lds
  v_and_b32 v202, s94, v189
  buffer_load_dwordx4 v[202:203], s[64:67], 0 idxen offen offset:1024 lds
  v_and_b32 v204, s94, v190
  buffer_load_dwordx4 v[204:205], s[68:71], 0 idxen offen offset:2048 lds
  v_and_b32 v206, s94, v191
  buffer_load_dwordx4 v[206:207], s[72:75], 0 idxen offen offset:3072 lds
  s_mov_b32 m0, s18
  s_add_u32 s18, s18, 256
  buffer_load_dword v[198:199], s[32:35], 0 idxen offen lds
L_d2:
  v_alignbit_b32 v138, v99, v98, v138
  v_dot2_f32_bf16 v120, v98, v152, v120
  v_dot2_f32_bf16 v132, v99, v152, v132
  v_dot2_f32_bf16 v121, v138, s62, v121
  v_alignbit_b32 v139, v103, v102, v139
  v_dot2_f32_bf16 v122, v102, v153, v122
  v_dot2_f32_bf16 v133, v103, v153, v133
  v_dot2_f32_bf16 v123, v139, s62, v123
  v_alignbit_b32 v140, v107, v106, v140
  v_dot2_f32_bf16 v124, v106, v154, v124
  v_dot2_f32_bf16 v134, v107, v154, v134
  v_dot2_f32_bf16 v125, v140, s62, v125
  v_add_u32 v61, s5, v61
  s_nop 1
  v_cvt_pk_bf16_f32 v98, 1.0, v120
  v_cvt_pk_bf16_f32 v99, v121, v132
  v_cvt_pk_bf16_f32 v102, 1.0, v122
  v_cvt_pk_bf16_f32 v103, v123, v133
  v_cvt_pk_bf16_f32 v106, 1.0, v124
  v_cvt_pk_bf16_f32 v107, v125, v134
  v_dot2_f32_bf16 v132, v99, v99, -1.0
  v_dot2_f32_bf16 v133, v103, v103, -1.0
  v_dot2_f32_bf16 v134, v107, v107, -1.0
  v_dot2_f32_bf16 v132, v98, v98, v132
  v_dot2_f32_bf16 v133, v102, v102, v133
  v_dot2_f32_bf16 v134, v106, v106, v134
  s_sub_u32 s9, s11, s10
  s_lshl_b32 s9, s9, 5
  s_mov_b32 s13, s12
  v_cvt_pk_bf16_f32 v132, 0, v132
  v_cvt_pk_bf16_f32 v133, 0, v133
  v_cvt_pk_bf16_f32 v134, 0, v134
  v_or_b32 v97, v158, v132
  v_or_b32 v101, v159, v133
  v_or_b32 v105, v160, v134
  v_cmpx_gt_i32 vcc, s9, v1
  ds_write_b128 v2, v[96:99] offset:7168
  s_sub_u32 s9, s9, 64
  v_cmpx_gt_i32 vcc, s9, v1
  ds_write_b128 v2, v[100:103] offset:8192
  s_sub_u32 s9, s9, 64
  v_cmpx_gt_i32 vcc, s9, v1
  ds_write_b128 v2, v[104:107] offset:9216
  s_sub_u32 s9, s9, 64
  s_mov_b64 exec, -1
  ds_read_b32 v196, v62 offset:7168
  ds_read2_b32 v[188:189], v60 offset0:129 offset1:161
  ds_read2_b32 v[190:191], v60 offset0:193 offset1:225
  s_lshl_b32 s56, s10, 8
  s_add_u32 s56, s56, 126720
  s_sub_u32 s8, s56, s18
  s_mov_b32 s18, s56
  v_alignbit_b32 v141, v111, v110, v141
  v_dot2_f32_bf16 v126, v110, v155, v126
  v_dot2_f32_bf16 v135, v111, v155, v135
  v_dot2_f32_bf16 v127, v141, s62, v127
  v_alignbit_b32 v142, v115, v114, v142
  v_dot2_f32_bf16 v128, v114, v156, v128
  v_dot2_f32_bf16 v136, v115, v156, v136
  v_dot2_f32_bf16 v129, v142, s62, v129
  v_alignbit_b32 v143, v119, v118, v143
  v_dot2_f32_bf16 v130, v118, v157, v130
  v_dot2_f32_bf16 v137, v119, v157, v137
  v_dot2_f32_bf16 v131, v143, s62, v131
  s_lshl_b32 s56, s12, 29
  s_add_u32 s56, s56, s5
  v_add_u32 v197, s56, v197
  v_cvt_pk_bf16_f32 v110, 1.0, v126
  v_cvt_pk_bf16_f32 v111, v127, v135
  v_cvt_pk_bf16_f32 v114, 1.0, v128
  v_cvt_pk_bf16_f32 v115, v129, v136
  v_cvt_pk_bf16_f32 v118, 1.0, v130
  v_cvt_pk_bf16_f32 v119, v131, v137
  v_dot2_f32_bf16 v135, v111, v111, -1.0
  v_dot2_f32_bf16 v136, v115, v115, -1.0
  v_dot2_f32_bf16 v137, v119, v119, -1.0
  v_dot2_f32_bf16 v135, v110, v110, v135
  v_dot2_f32_bf16 v136, v114, v114, v136
  v_dot2_f32_bf16 v137, v118, v118, v137
  s_mov_b64 exec, s[60:61]
  v_add_u32 v63, s5, v63
  s_mov_b64 exec, -1
  v_cvt_pk_bf16_f32 v135, 0, v135
  v_cvt_pk_bf16_f32 v136, 0, v136
  v_cvt_pk_bf16_f32 v137, 0, v137
  v_or_b32 v109, v161, v135
  v_or_b32 v113, v162, v136
  v_or_b32 v117, v163, v137
  v_cmpx_gt_i32 vcc, s9, v1
  ds_write_b128 v2, v[108:111] offset:10240
  s_sub_u32 s9, s9, 64
  v_cmpx_gt_i32 vcc, s9, v1
  ds_write_b128 v2, v[112:115] offset:11264
  s_sub_u32 s9, s9, 64
  v_cmpx_gt_i32 vcc, s9, v1
  ds_write_b128 v2, v[116:119] offset:12288
  s_mov_b64 exec, -1
  v_add_u32 v60, 1024, v60
  v_mov_b32 v180, 0
  v_mov_b32 v181, 0
  v_mov_b32 v182, 0
  v_mov_b32 v183, 0
  v_mov_b32 v184, 0
  v_mov_b32 v185, 0
  v_mov_b32 v186, 0
  v_mov_b32 v187, 0
  v_mov_b32 v144, 0
  v_mov_b32 v145, 0
  v_mov_b32 v146, 0
  v_mov_b32 v147, 0
  v_mov_b32 v148, 0
  v_mov_b32 v149, 0
  v_mov_b32 v150, 0
  v_mov_b32 v151, 0
  s_waitcnt lgkmcnt(2)
  v_and_b32_sdwa v196, v196, 28 dst_sel:DWORD dst_unused:UNUSED_PAD src0_sel:BYTE_3 src1_sel:DWORD
  v_xor_b32 v196, v196, v208
  s_waitcnt vmcnt(0)
  ds_read_b128 v[160:163], v56
  ds_read_b128 v[164:167], v57
  ds_read_b128 v[168:171], v58
  ds_read_b128 v[172:175], v59
  ds_read2_b32 v[176:177], v196 offset0:0 offset1:8
  ds_read2_b32 v[178:179], v63 offset0:0 offset1:1
  s_add_u32 s56, s10, 1
  s_cmp_lt_u32 s56, s11
  v_add_u32 v63, v63, v251
  s_mov_b32 exec_hi, 0
  v_add_u32 v63, s8, v63
  s_mov_b32 exec_hi, -1
  s_waitcnt lgkmcnt(0)
  v_cndmask_b32 v179, v179, v178, s[60:61]
  v_mfma_f32_32x32x16_bf16 v[96:111], v[160:163], v[4:7], 0
  v_mfma_f32_32x32x16_bf16 v[96:111], v[164:167], v[8:11], v[96:111]
  v_mfma_f32_32x32x16_bf16 v[96:111], v[168:171], v[12:15], v[96:111]
  v_mfma_f32_32x32x16_bf16 v[96:111], v[172:175], v[16:19], v[96:111]
  v_mfma_f32_32x32x16_bf16 v[96:111], v[176:179], v[36:39], v[96:111]
  s_cbranch_scc0 L_fill_nodma
  s_add_u32 m0, s16, 0
  v_and_b32 v200, s94, v188
  buffer_load_dwordx4 v[200:201], s[28:31], 0 idxen offen lds
  v_and_b32 v202, s94, v189
  buffer_load_dwordx4 v[202:203], s[64:67], 0 idxen offen offset:1024 lds
  v_and_b32 v204, s94, v190
  buffer_load_dwordx4 v[204:205], s[68:71], 0 idxen offen offset:2048 lds
  v_and_b32 v206, s94, v191
  buffer_load_dwordx4 v[206:207], s[72:75], 0 idxen offen offset:3072 lds
L_fill_nodma:
  v_mov_b32 v188, 0
  v_mov_b32 v189, 0
  v_mov_b32 v190, 0
  v_mov_b32 v191, 0
  s_mov_b32 m0, s18
  s_add_u32 s18, s18, 256
  buffer_load_dword v[192:193], s[32:35], 0 idxen offen lds
  s_mov_b32 m0, s18
  s_add_u32 s18, s18, 256
  buffer_load_dword v[194:195], s[32:35], 0 idxen offen lds
  ds_read_b32 v196, v62 offset:7680
  ds_read_u16 v200, v60 offset:4
  ds_read_u16 v202, v60 offset:132
  ds_read_u16 v204, v60 offset:260
  ds_read_u16 v206, v60 offset:388
  ds_read2_b32 v[192:193], v61 offset0:0 offset1:32
  ds_read2_b32 v[194:195], v61 offset0:64 offset1:96
  ds_read_b32 v198, v250 offset:8704
  s_setprio 1
  v_mfma_f32_32x32x16_bf16 v[112:127], v[160:163], v[20:23], 0
  v_exp_f32 v143, v111
  v_exp_f32 v142, v110
  v_exp_f32 v141, v109
  v_mfma_f32_32x32x16_bf16 v[112:127], v[164:167], v[24:27], v[112:127]
  v_exp_f32 v140, v108
  v_exp_f32 v139, v107
  v_exp_f32 v138, v106
  v_mfma_f32_32x32x16_bf16 v[112:127], v[168:171], v[28:31], v[112:127]
  v_exp_f32 v137, v105
  v_exp_f32 v136, v104
  v_exp_f32 v135, v103
  v_mfma_f32_32x32x16_bf16 v[112:127], v[172:175], v[32:35], v[112:127]
  v_exp_f32 v134, v102
  v_exp_f32 v133, v101
  v_exp_f32 v132, v100
  v_mfma_f32_32x32x16_bf16 v[112:127], v[176:179], v[40:43], v[112:127]
  v_exp_f32 v131, v99
  v_exp_f32 v130, v98
  v_exp_f32 v129, v97
  v_exp_f32 v128, v96
  s_waitcnt lgkmcnt(0)
  v_and_b32_sdwa v196, v196, 28 dst_sel:DWORD dst_unused:UNUSED_PAD src0_sel:BYTE_3 src1_sel:DWORD
  v_xor_b32 v196, v196, v208
  v_and_b32 v198, 0xfffff, v198
  v_mfma_f32_32x32x8_bf16 v[128:143], v[212:213], v[212:213], v[128:143]
  v_bitop3_b32 v192, v192, s95, v197 bitop3:0x6a
  v_bitop3_b32 v193, v193, s95, v197 bitop3:0x6a
  v_bitop3_b32 v194, v194, s95, v197 bitop3:0x6a
  v_bitop3_b32 v195, v195, s95, v197 bitop3:0x6a
  s_nop 7
  v_rcp_f32 v128, v128
  v_rcp_f32 v129, v129
  v_rcp_f32 v130, v130
  v_rcp_f32 v131, v131
  v_rcp_f32 v132, v132
  v_rcp_f32 v133, v133
  v_rcp_f32 v134, v134
  v_rcp_f32 v135, v135
  v_rcp_f32 v136, v136
  v_rcp_f32 v137, v137
  v_rcp_f32 v138, v138
  v_rcp_f32 v139, v139
  v_rcp_f32 v140, v140
  v_rcp_f32 v141, v141
  v_rcp_f32 v142, v142
  v_rcp_f32 v143, v143
  s_sub_u32 s14, s11, 1
  s_branch L_E1
  .p2align 6
L_loop:
  v_exp_f32 v143, v111
  v_mfma_f32_32x32x16_bf16 v[64:79], v[128:131], v[180:183], v[64:79]
  v_exp_f32 v142, v110
  v_exp_f32 v141, v109
  v_exp_f32 v140, v108
  v_exp_f32 v139, v107
  v_mfma_f32_32x32x16_bf16 v[64:79], v[132:135], v[184:187], v[64:79]
  v_exp_f32 v138, v106
  v_exp_f32 v137, v105
  v_exp_f32 v136, v104
  v_exp_f32 v135, v103
  v_exp_f32 v134, v102
  v_exp_f32 v133, v101
  v_exp_f32 v132, v100
  v_exp_f32 v131, v99
  v_exp_f32 v130, v98
  v_exp_f32 v129, v97
  v_exp_f32 v128, v96
  s_setprio 0
  ds_read_b32 v196, v62 offset:7680
  ds_read_u16 v200, v60 offset:4
  ds_read_u16 v202, v60 offset:132
  ds_read_u16 v204, v60 offset:260
  ds_read_u16 v206, v60 offset:388
  ds_read2_b32 v[192:193], v61 offset0:0 offset1:32
  ds_read2_b32 v[194:195], v61 offset0:64 offset1:96
  ds_read_b32 v198, v250 offset:8704
  v_mul_f32 v144, v144, v112
  v_mul_f32 v145, v145, v113
  v_mfma_f32_32x32x8_bf16 v[128:143], v[212:213], v[212:213], v[128:143]
  v_mul_f32 v146, v146, v114
  v_mul_f32 v147, v147, v115
  v_mul_f32 v148, v148, v116
  v_mul_f32 v149, v149, v117
  v_mul_f32 v150, v150, v118
  v_mul_f32 v151, v151, v119
  v_mul_f32 v152, v152, v120
  v_mul_f32 v153, v153, v121
  v_mul_f32 v154, v154, v122
  v_mul_f32 v155, v155, v123
  v_mul_f32 v156, v156, v124
  v_mul_f32 v157, v157, v125
  v_mul_f32 v158, v158, v126
  v_mul_f32 v159, v159, v127
  s_waitcnt lgkmcnt(0)
  s_setprio 1
  v_mfma_f32_32x32x16_bf16 v[112:127], v[160:163], v[20:23], 0
  v_cvt_pk_bf16_f32 v144, v144, v145
  v_cvt_pk_bf16_f32 v145, v146, v147
  v_cvt_pk_bf16_f32 v146, v148, v149
  v_cvt_pk_bf16_f32 v147, v150, v151
  v_cvt_pk_bf16_f32 v148, v152, v153
  v_cvt_pk_bf16_f32 v149, v154, v155
  v_mfma_f32_32x32x16_bf16 v[112:127], v[164:167], v[24:27], v[112:127]
  v_cvt_pk_bf16_f32 v150, v156, v157
  v_cvt_pk_bf16_f32 v151, v158, v159
  v_rcp_f32 v128, v128
  v_rcp_f32 v129, v129
  v_mfma_f32_32x32x16_bf16 v[112:127], v[168:171], v[28:31], v[112:127]
  v_rcp_f32 v130, v130
  v_rcp_f32 v131, v131
  v_rcp_f32 v132, v132
  v_mfma_f32_32x32x16_bf16 v[112:127], v[172:175], v[32:35], v[112:127]
  v_rcp_f32 v133, v133
  v_rcp_f32 v134, v134
  v_rcp_f32 v135, v135
  v_mfma_f32_32x32x16_bf16 v[112:127], v[176:179], v[40:43], v[112:127]
  v_rcp_f32 v136, v136
  v_rcp_f32 v137, v137
  v_rcp_f32 v138, v138
  v_rcp_f32 v139, v139
  v_rcp_f32 v140, v140
  v_rcp_f32 v141, v141
  v_rcp_f32 v142, v142
  v_rcp_f32 v143, v143
  v_and_b32_sdwa v196, v196, 28 dst_sel:DWORD dst_unused:UNUSED_PAD src0_sel:BYTE_3 src1_sel:DWORD
  v_xor_b32 v196, v196, v208
  v_and_b32 v198, 0xfffff, v198
  v_bitop3_b32 v192, v192, s95, v197 bitop3:0x6a
  v_bitop3_b32 v193, v193, s95, v197 bitop3:0x6a
  v_bitop3_b32 v194, v194, s95, v197 bitop3:0x6a
  v_bitop3_b32 v195, v195, s95, v197 bitop3:0x6a
L_E1:
  v_exp_f32 v159, v127
  v_mfma_f32_32x32x16_bf16 v[80:95], v[144:147], v[180:183], v[80:95]
  v_exp_f32 v158, v126
  v_exp_f32 v157, v125
  v_exp_f32 v156, v124
  v_exp_f32 v155, v123
  v_mfma_f32_32x32x16_bf16 v[80:95], v[148:151], v[184:187], v[80:95]
  v_exp_f32 v154, v122
  v_exp_f32 v153, v121
  v_exp_f32 v152, v120
  v_exp_f32 v151, v119
  v_exp_f32 v150, v118
  v_exp_f32 v149, v117
  v_exp_f32 v148, v116
  v_exp_f32 v147, v115
  v_exp_f32 v146, v114
  v_exp_f32 v145, v113
  v_exp_f32 v144, v112
  s_setprio 0
  ds_read_b64_tr_b16 v[180:181], v192 offset:8
  ds_read_b64_tr_b16 v[182:183], v193 offset:136
  ds_read_b64_tr_b16 v[184:185], v194 offset:264
  ds_read_b64_tr_b16 v[186:187], v195 offset:392
  s_waitcnt vmcnt(1)
  ds_read_b128 v[160:163], v56
  ds_read_b128 v[164:167], v57
  ds_read_b128 v[168:171], v58
  ds_read_b128 v[172:175], v59
  ds_read2_b32 v[176:177], v196 offset0:0 offset1:8
  ds_read2_b32 v[178:179], v63 offset0:0 offset1:1
  s_add_u32 s10, s10, 1
  s_movk_i32 s17, 0x200
  s_cmp_lg_u32 s13, s12
  s_cbranch_scc1 L_flush
L_flush_back:
  s_cmp_ge_u32 s10, s15
  s_cbranch_scc1 L_newgrp
L_newgrp_back:
  s_mov_b32 m0, s16
  s_cmp_lt_u32 s10, s14
  s_waitcnt lgkmcnt(0)
  s_cbranch_scc0 L_nodma
  buffer_load_dwordx4 v[200:201], s[28:31], 0 idxen offen lds
  buffer_load_dwordx4 v[202:203], s[64:67], 0 idxen offen offset:1024 lds
  buffer_load_dwordx4 v[204:205], s[68:71], 0 idxen offen offset:2048 lds
  buffer_load_dwordx4 v[206:207], s[72:75], 0 idxen offen offset:3072 lds
L_nodma:
  s_mov_b32 m0, s18
  s_add_u32 s18, s18, 256
  buffer_load_dword v[198:199], s[32:35], 0 idxen offen lds
  v_mul_f32 v128, v128, v96
  v_mul_f32 v129, v129, v97
  v_mfma_f32_32x32x8_bf16 v[144:159], v[212:213], v[212:213], v[144:159]
  v_mul_f32 v130, v130, v98
  v_mul_f32 v131, v131, v99
  v_mul_f32 v132, v132, v100
  v_mul_f32 v133, v133, v101
  v_mul_f32 v134, v134, v102
  v_mul_f32 v135, v135, v103
  v_mul_f32 v136, v136, v104
  v_mul_f32 v137, v137, v105
  v_mul_f32 v138, v138, v106
  v_mul_f32 v139, v139, v107
  v_mul_f32 v140, v140, v108
  v_mul_f32 v141, v141, v109
  v_mul_f32 v142, v142, v110
  v_mul_f32 v143, v143, v111
  s_cmp_lt_u32 s10, s11
  s_setprio 1
  v_mfma_f32_32x32x16_bf16 v[96:111], v[160:163], v[4:7], 0
  v_cvt_pk_bf16_f32 v128, v128, v129
  v_cvt_pk_bf16_f32 v129, v130, v131
  v_cvt_pk_bf16_f32 v130, v132, v133
  v_cvt_pk_bf16_f32 v131, v134, v135
  v_cvt_pk_bf16_f32 v132, v136, v137
  v_cvt_pk_bf16_f32 v133, v138, v139
  v_mfma_f32_32x32x16_bf16 v[96:111], v[164:167], v[8:11], v[96:111]
  v_cvt_pk_bf16_f32 v134, v140, v141
  v_cvt_pk_bf16_f32 v135, v142, v143
  v_rcp_f32 v144, v144
  v_rcp_f32 v145, v145
  v_mfma_f32_32x32x16_bf16 v[96:111], v[168:171], v[12:15], v[96:111]
  v_rcp_f32 v146, v146
  v_rcp_f32 v147, v147
  v_rcp_f32 v148, v148
  v_mfma_f32_32x32x16_bf16 v[96:111], v[172:175], v[16:19], v[96:111]
  v_rcp_f32 v149, v149
  v_cndmask_b32 v179, v179, v178, s[60:61]
  v_rcp_f32 v150, v150
  v_rcp_f32 v151, v151
  v_mfma_f32_32x32x16_bf16 v[96:111], v[176:179], v[36:39], v[96:111]
  v_rcp_f32 v152, v152
  v_rcp_f32 v153, v153
  v_rcp_f32 v154, v154
  v_rcp_f32 v155, v155
  v_rcp_f32 v156, v156
  v_rcp_f32 v157, v157
  v_rcp_f32 v158, v158
  v_rcp_f32 v159, v159
  v_add_f32 v60, 0x200, v60
  v_add_f32 v61, 0x200, v61
  v_add_f32 v62, 0x200, v62
  v_add_f32 v250, 0x200, v250
  v_add_f32 v63, v63, v251
  v_add_u32 v197, s17, v197
  s_cbranch_scc1 L_loop
  s_setprio 0
  v_mul_f32 v144, v144, v112
  v_mfma_f32_32x32x16_bf16 v[64:79], v[128:131], v[180:183], v[64:79]
  v_mul_f32 v145, v145, v113
  v_mul_f32 v146, v146, v114
  v_mul_f32 v147, v147, v115
  v_mul_f32 v148, v148, v116
  v_mul_f32 v149, v149, v117
  v_mul_f32 v150, v150, v118
  v_mul_f32 v151, v151, v119
  v_mfma_f32_32x32x16_bf16 v[64:79], v[132:135], v[184:187], v[64:79]
  v_mul_f32 v152, v152, v120
  v_mul_f32 v153, v153, v121
  v_mul_f32 v154, v154, v122
  v_mul_f32 v155, v155, v123
  v_mul_f32 v156, v156, v124
  v_mul_f32 v157, v157, v125
  v_mul_f32 v158, v158, v126
  v_mul_f32 v159, v159, v127
  v_cvt_pk_bf16_f32 v144, v144, v145
  v_cvt_pk_bf16_f32 v145, v146, v147
  v_cvt_pk_bf16_f32 v146, v148, v149
  v_cvt_pk_bf16_f32 v147, v150, v151
  v_cvt_pk_bf16_f32 v148, v152, v153
  v_cvt_pk_bf16_f32 v149, v154, v155
  v_cvt_pk_bf16_f32 v150, v156, v157
  v_cvt_pk_bf16_f32 v151, v158, v159
  s_add_u32 s57, s13, s63
  s_mul_i32 s56, s57, 2432
  v_mfma_f32_32x32x16_bf16 v[80:95], v[144:147], v[180:183], v[80:95]
  v_mfma_f32_32x32x16_bf16 v[80:95], v[148:151], v[184:187], v[80:95]
  v_add_u32 v211, s56, v209
  v_add_u32 v214, s56, v210
  s_lshl_b32 s57, 1, s57
  s_lshl_b32 s56, s13, 2
  v_mov_b32 v194, s56
  v_mov_b32 v195, s57
  s_mov_b64 exec, 1
  ds_or_b32 v194, v195 offset:1376
  s_mov_b32 exec_lo, 0x11111111
  s_mov_b32 exec_hi, 0x11111111
  ds_write_b128 v211, v[64:67] offset:0
  ds_write_b128 v211, v[68:71] offset:32
  ds_write_b128 v211, v[72:75] offset:64
  ds_write_b128 v211, v[76:79] offset:96
  s_mov_b64 exec, -1
  v_pk_mul_f32 v[2:3], v[216:217], v[64:65]
  v_pk_mul_f32 v[192:193], v[218:219], v[66:67]
  v_pk_fma_f32 v[2:3], v[220:221], v[68:69], v[2:3]
  v_pk_fma_f32 v[192:193], v[222:223], v[70:71], v[192:193]
  v_pk_fma_f32 v[2:3], v[224:225], v[72:73], v[2:3]
  v_pk_fma_f32 v[192:193], v[226:227], v[74:75], v[192:193]
  v_pk_fma_f32 v[2:3], v[228:229], v[76:77], v[2:3]
  v_pk_fma_f32 v[192:193], v[230:231], v[78:79], v[192:193]
  s_mov_b32 exec_lo, 0x11111111
  s_mov_b32 exec_hi, 0x11111111
  ds_write_b128 v211, v[80:83] offset:128
  ds_write_b128 v211, v[84:87] offset:160
  ds_write_b128 v211, v[88:91] offset:192
  ds_write_b128 v211, v[92:95] offset:224
  s_mov_b64 exec, -1
  v_pk_fma_f32 v[2:3], v[232:233], v[80:81], v[2:3]
  v_pk_fma_f32 v[192:193], v[234:235], v[82:83], v[192:193]
  v_pk_fma_f32 v[2:3], v[236:237], v[84:85], v[2:3]
  v_pk_fma_f32 v[192:193], v[238:239], v[86:87], v[192:193]
  v_pk_fma_f32 v[2:3], v[240:241], v[88:89], v[2:3]
  v_pk_fma_f32 v[192:193], v[242:243], v[90:91], v[192:193]
  v_pk_fma_f32 v[2:3], v[244:245], v[92:93], v[2:3]
  v_pk_fma_f32 v[192:193], v[246:247], v[94:95], v[192:193]
  v_pk_add_f32 v[2:3], v[2:3], v[192:193]
  v_add_f32 v2, v2, v3
  ds_write_b32 v214, v2
L_fin:
  s_cmp_ge_u32 s3, 6
  s_cbranch_scc1 L_posw
  ds_read_b64_tr_b16 v[120:121], v255 offset:32768
  ds_read_b64_tr_b16 v[122:123], v255 offset:33280
  ds_read_b64_tr_b16 v[124:125], v255 offset:36864
  ds_read_b64_tr_b16 v[126:127], v255 offset:37376
  ds_read_b64_tr_b16 v[128:129], v255 offset:32776
  ds_read_b64_tr_b16 v[130:131], v255 offset:33288
  ds_read_b64_tr_b16 v[132:133], v255 offset:36872
  ds_read_b64_tr_b16 v[134:135], v255 offset:37384
  v_and_b32 v64, 15, v1
  v_lshrrev_b32 v65, 4, v1
  s_lshr_b32 s16, s3, 1
  s_lshl_b32 s18, s16, 4
  v_add_u32 v66, s18, v64
  v_lshrrev_b32 v67, 3, v66
  v_lshlrev_b32 v67, 2, v67
  v_and_b32 v68, 7, v64
  v_mul_u32_u24 v68, 272, v68
  v_lshl_add_u32 v68, v65, 5, v68
  v_add_u32 v68, 97280, v68
  v_lshlrev_b32 v69, 7, v66
  v_lshl_add_u32 v69, v65, 4, v69
  s_and_b32 s57, s3, 1
  s_lshl_b32 s17, s27, 7
  s_lshl_b32 s56, s57, 6
  s_add_u32 s17, s17, s56
  s_movk_i32 s18, 2432
  s_mov_b32 s19, 0xbf317218
  s_mov_b32 s4, 0xffff0000
  s_mov_b32 s5, 0xbfb8aa3b
  v_lshlrev_b32 v136, 16, v52
  v_and_b32 v137, s4, v52
  v_lshlrev_b32 v138, 16, v53
  v_and_b32 v139, s4, v53
  v_lshlrev_b32 v140, 16, v54
  v_and_b32 v141, s4, v54
  v_lshlrev_b32 v142, 16, v55
  v_and_b32 v143, s4, v55
  s_waitcnt vmcnt(0) lgkmcnt(0)
  s_barrier
  ds_read_b32 v71, v67 offset:1376
  s_waitcnt lgkmcnt(0)
  v_ffbl_b32 v2, v71
  v_add_u32 v3, -1, v71
  v_mad_u32_u24 v2, v2, s18, v68
  v_and_b32 v71, v3, v71
  ds_read_b128 v[72:75], v2 offset:0
  ds_read_b128 v[76:79], v2 offset:16
  ds_read_b128 v[80:83], v2 offset:128
  ds_read_b128 v[84:87], v2 offset:144
  v_ffbl_b32 v2, v71
  v_add_u32 v3, -1, v71
  v_mad_u32_u24 v2, v2, s18, v68
  v_and_b32 v71, v3, v71
  ds_read_b128 v[88:91], v2 offset:0
  ds_read_b128 v[92:95], v2 offset:16
  ds_read_b128 v[96:99], v2 offset:128
  ds_read_b128 v[100:103], v2 offset:144
  v_ffbl_b32 v2, v71
  v_add_u32 v3, -1, v71
  v_mad_u32_u24 v2, v2, s18, v68
  v_and_b32 v71, v3, v71
  ds_read_b128 v[104:107], v2 offset:0
  ds_read_b128 v[108:111], v2 offset:16
  ds_read_b128 v[112:115], v2 offset:128
  ds_read_b128 v[116:119], v2 offset:144
  v_cmp_ne_u32 vcc, 0, v71
  s_waitcnt lgkmcnt(4)
  v_add_f32 v72, v72, v88
  v_add_f32 v73, v73, v89
  v_add_f32 v74, v74, v90
  v_add_f32 v75, v75, v91
  v_add_f32 v76, v76, v92
  v_add_f32 v77, v77, v93
  v_add_f32 v78, v78, v94
  v_add_f32 v79, v79, v95
  v_add_f32 v80, v80, v96
  v_add_f32 v81, v81, v97
  v_add_f32 v82, v82, v98
  v_add_f32 v83, v83, v99
  v_add_f32 v84, v84, v100
  v_add_f32 v85, v85, v101
  v_add_f32 v86, v86, v102
  v_add_f32 v87, v87, v103
  s_waitcnt lgkmcnt(0)
  v_add_f32 v72, v72, v104
  v_add_f32 v73, v73, v105
  v_add_f32 v74, v74, v106
  v_add_f32 v75, v75, v107
  v_add_f32 v76, v76, v108
  v_add_f32 v77, v77, v109
  v_add_f32 v78, v78, v110
  v_add_f32 v79, v79, v111
  v_add_f32 v80, v80, v112
  v_add_f32 v81, v81, v113
  v_add_f32 v82, v82, v114
  v_add_f32 v83, v83, v115
  v_add_f32 v84, v84, v116
  v_add_f32 v85, v85, v117
  v_add_f32 v86, v86, v118
  v_add_f32 v87, v87, v119
  s_cbranch_vccnz L_more
L_more_back:
  s_cmp_lg_u32 s53, 0
  s_cbranch_scc1 L_slow_n
L_final_n:
  v_mul_f32 v72, s19, v72
  v_mul_f32 v73, s19, v73
  v_mul_f32 v74, s19, v74
  v_mul_f32 v75, s19, v75
  v_mul_f32 v76, s19, v76
  v_mul_f32 v77, s19, v77
  v_mul_f32 v78, s19, v78
  v_mul_f32 v79, s19, v79
  v_mul_f32 v80, s19, v80
  v_mul_f32 v81, s19, v81
  v_mul_f32 v82, s19, v82
  v_mul_f32 v83, s19, v83
  v_mul_f32 v84, s19, v84
  v_mul_f32 v85, s19, v85
  v_mul_f32 v86, s19, v86
  v_mul_f32 v87, s19, v87
  v_cvt_pk_bf16_f32 v72, v72, v73
  v_cvt_pk_bf16_f32 v73, v74, v75
  v_cvt_pk_bf16_f32 v74, v76, v77
  v_cvt_pk_bf16_f32 v75, v78, v79
  v_cvt_pk_bf16_f32 v76, v80, v81
  v_cvt_pk_bf16_f32 v77, v82, v83
  v_cvt_pk_bf16_f32 v78, v84, v85
  v_cvt_pk_bf16_f32 v79, v86, v87
  v_cmp_gt_u32 vcc, s52, v66
  s_nop 0
  v_mfma_f32_16x16x32_bf16 v[44:47], v[120:123], v[72:75], v[44:47]
  v_mfma_f32_16x16x32_bf16 v[48:51], v[128:131], v[72:75], v[48:51]
  v_mfma_f32_16x16x32_bf16 v[44:47], v[124:127], v[76:79], v[44:47]
  v_mfma_f32_16x16x32_bf16 v[48:51], v[132:135], v[76:79], v[48:51]
  s_nop 6
  v_cvt_pk_bf16_f32 v88, v44, v45
  v_cvt_pk_bf16_f32 v89, v46, v47
  v_cvt_pk_bf16_f32 v90, v48, v49
  v_cvt_pk_bf16_f32 v91, v50, v51
  v_lshlrev_b32 v72, 16, v88
  v_and_b32 v73, s4, v88
  v_lshlrev_b32 v74, 16, v89
  v_and_b32 v75, s4, v89
  v_lshlrev_b32 v76, 16, v90
  v_and_b32 v77, s4, v90
  v_lshlrev_b32 v78, 16, v91
  v_and_b32 v79, s4, v91
  v_mul_f32 v80, s5, v72
  v_mul_f32 v81, s5, v73
  v_mul_f32 v82, s5, v74
  v_mul_f32 v83, s5, v75
  v_mul_f32 v84, s5, v76
  v_mul_f32 v85, s5, v77
  v_mul_f32 v86, s5, v78
  v_mul_f32 v87, s5, v79
  v_exp_f32 v80, v80
  v_exp_f32 v81, v81
  v_exp_f32 v82, v82
  v_exp_f32 v83, v83
  v_exp_f32 v84, v84
  v_exp_f32 v85, v85
  v_exp_f32 v86, v86
  v_exp_f32 v87, v87
  v_add_f32 v80, 1.0, v80
  v_add_f32 v81, 1.0, v81
  v_add_f32 v82, 1.0, v82
  v_add_f32 v83, 1.0, v83
  v_add_f32 v84, 1.0, v84
  v_add_f32 v85, 1.0, v85
  v_add_f32 v86, 1.0, v86
  v_add_f32 v87, 1.0, v87
  v_rcp_f32 v80, v80
  v_rcp_f32 v81, v81
  v_rcp_f32 v82, v82
  v_rcp_f32 v83, v83
  v_rcp_f32 v84, v84
  v_rcp_f32 v85, v85
  v_rcp_f32 v86, v86
  v_rcp_f32 v87, v87
  v_mul_f32 v80, v80, v72
  v_mul_f32 v81, v81, v73
  v_mul_f32 v82, v82, v74
  v_mul_f32 v83, v83, v75
  v_mul_f32 v84, v84, v76
  v_mul_f32 v85, v85, v77
  v_mul_f32 v86, v86, v78
  v_mul_f32 v87, v87, v79
  v_cvt_pk_bf16_f32 v88, v80, v81
  v_cvt_pk_bf16_f32 v89, v82, v83
  v_cvt_pk_bf16_f32 v90, v84, v85
  v_cvt_pk_bf16_f32 v91, v86, v87
  v_lshlrev_b32 v72, 16, v88
  v_and_b32 v73, s4, v88
  v_lshlrev_b32 v74, 16, v89
  v_and_b32 v75, s4, v89
  v_lshlrev_b32 v76, 16, v90
  v_and_b32 v77, s4, v90
  v_lshlrev_b32 v78, 16, v91
  v_and_b32 v79, s4, v91
  v_add_f32 v72, v72, v136
  v_add_f32 v73, v73, v137
  v_add_f32 v74, v74, v138
  v_add_f32 v75, v75, v139
  v_add_f32 v76, v76, v140
  v_add_f32 v77, v77, v141
  v_add_f32 v78, v78, v142
  v_add_f32 v79, v79, v143
  v_cvt_pk_bf16_f32 v88, v72, v73
  v_cvt_pk_bf16_f32 v89, v74, v75
  v_cvt_pk_bf16_f32 v90, v76, v77
  v_cvt_pk_bf16_f32 v91, v78, v79
  s_mov_b64 exec, vcc
  buffer_store_dwordx4 v[88:91], v69, s[48:51], s17 offen
L_done:
  s_endpgm
L_posw:
  s_sub_u32 s16, s3, 6
  s_lshl_b32 s16, s16, 6
  v_add_u32 v64, s16, v1
  v_mul_u32_u24 v66, 21846, v64
  v_lshrrev_b32 v66, 16, v66
  v_mul_u32_u24 v65, 3, v66
  v_sub_u32 v65, v64, v65
  v_lshlrev_b32 v69, 1, v64
  s_mul_i32 s17, s27, 6
  v_lshlrev_b32 v70, 2, v66
  v_lshl_add_u32 v70, v65, 8, v70
  ds_read_b32 v70, v70 offset:256
  v_lshrrev_b32 v67, 3, v66
  v_lshlrev_b32 v67, 2, v67
  v_and_b32 v68, 7, v66
  v_lshl_add_u32 v68, v68, 2, v65
  v_lshlrev_b32 v68, 3, v68
  v_add_u32 v68, 99464, v68
  s_movk_i32 s18, 2432
  s_waitcnt vmcnt(0) lgkmcnt(0)
  s_barrier
  ds_read_b32 v71, v67 offset:1376
  v_mov_b32 v72, 0
  s_waitcnt lgkmcnt(0)
L_posloop:
  v_ffbl_b32 v2, v71
  v_add_u32 v3, -1, v71
  v_mad_u32_u24 v2, v2, s18, v68
  v_and_b32 v71, v3, v71
  ds_read_b64 v[88:89], v2 offset:0
  v_ffbl_b32 v2, v71
  v_add_u32 v3, -1, v71
  v_mad_u32_u24 v2, v2, s18, v68
  v_and_b32 v71, v3, v71
  ds_read_b64 v[90:91], v2 offset:0
  v_ffbl_b32 v2, v71
  v_add_u32 v3, -1, v71
  v_mad_u32_u24 v2, v2, s18, v68
  v_and_b32 v71, v3, v71
  ds_read_b64 v[92:93], v2 offset:0
  v_cmp_ne_u32 vcc, 0, v71
  s_waitcnt lgkmcnt(0)
  v_add_f32 v88, v88, v89
  v_add_f32 v90, v90, v91
  v_add_f32 v92, v92, v93
  v_add_f32 v72, v72, v88
  v_add_f32 v90, v90, v92
  v_add_f32 v72, v72, v90
  s_cbranch_vccnz L_posloop
  s_cmp_lg_u32 s53, 0
  s_cbranch_scc1 L_slow_p
L_final_p:
  v_cvt_pk_bf16_f32 v72, v72, v72
  v_lshlrev_b32 v72, 16, v72
  s_mul_i32 s16, s52, 3
  v_add_f32 v72, v72, v70
  v_cmp_gt_u32 vcc, s16, v64
  v_cvt_pk_bf16_f32 v72, v72, v72
  s_add_u32 s17, s17, 1280000
  s_mov_b64 exec, vcc
  buffer_store_short v72, v69, s[48:51], s17 offen
  s_cmp_lg_u32 s55, 0
  s_cbranch_scc1 L_latebump
L_latebump_back:
  s_endpgm
L_miss:
  s_add_u32 s47, s47, 1
  s_cmp_ge_u32 s47, 3000
  s_cbranch_scc1 L_timeout
  s_cmp_lg_u64 s[4:5], 0
  s_cbranch_scc0 L_miss0
  buffer_load_dwordx4 v[156:159], v215, s[36:39], 0 offen sc1
L_miss0:
  s_cmp_lg_u64 s[6:7], 0
  s_cbranch_scc0 L_miss1
  s_mov_b32 s56, 328704
  buffer_load_dwordx4 v[160:163], v215, s[36:39], s56 offen sc1
L_miss1:
  s_cmp_lg_u64 s[8:9], 0
  s_cbranch_scc0 L_miss2
  s_mov_b32 s56, 657408
  buffer_load_dwordx4 v[164:167], v215, s[36:39], s56 offen sc1
L_miss2:
  s_cmp_lg_u64 s[10:11], 0
  s_cbranch_scc0 L_miss3
  s_mov_b32 s56, 986112
  buffer_load_dwordx4 v[168:171], v215, s[36:39], s56 offen sc1
L_miss3:
  s_mov_b64 exec, -1
  s_waitcnt vmcnt(0)
  s_branch L_chk
L_timeout:
  s_lshl_b32 s14, s3, 2
  s_mov_b64 exec, -1
  v_lshrrev_b32 v176, 3, v1
  v_add_u32 v176, 0, v176
  s_mov_b64 exec, s[4:5]
  v_lshlrev_b32 v176, v176, 1
  v_mov_b32 v177, s14
  ds_or_b32 v177, v176 offset:1344
  s_mov_b64 exec, -1
  v_lshrrev_b32 v176, 3, v1
  v_add_u32 v176, 8, v176
  s_mov_b64 exec, s[6:7]
  v_lshlrev_b32 v176, v176, 1
  v_mov_b32 v177, s14
  ds_or_b32 v177, v176 offset:1344
  s_mov_b64 exec, -1
  v_lshrrev_b32 v176, 3, v1
  v_add_u32 v176, 16, v176
  s_mov_b64 exec, s[8:9]
  v_lshlrev_b32 v176, v176, 1
  v_mov_b32 v177, s14
  ds_or_b32 v177, v176 offset:1344
  s_mov_b64 exec, -1
  v_lshrrev_b32 v176, 3, v1
  v_add_u32 v176, 24, v176
  s_mov_b64 exec, s[10:11]
  v_lshlrev_b32 v176, v176, 1
  v_mov_b32 v177, s14
  ds_or_b32 v177, v176 offset:1344
  s_mov_b64 exec, -1
  s_lshl_b32 s14, s3, 2
  v_mov_b32 v177, s14
  s_waitcnt lgkmcnt(0)
  ds_read_b32 v176, v177 offset:1344
  v_lshrrev_b32 v177, 3, v1
  s_waitcnt lgkmcnt(0)
  v_lshrrev_b32 v176, v177, v176
  v_bfe_u32 v177, v176, 0, 1
  v_cmp_ne_u32 vcc, 0, v177
  s_andn2_b64 s[64:65], s[64:65], vcc
  s_andn2_b64 s[66:67], s[66:67], vcc
  s_andn2_b64 s[68:69], s[68:69], vcc
  v_bfe_u32 v177, v176, 8, 1
  v_cmp_ne_u32 vcc, 0, v177
  s_andn2_b64 s[70:71], s[70:71], vcc
  s_andn2_b64 s[72:73], s[72:73], vcc
  s_andn2_b64 s[74:75], s[74:75], vcc
  v_bfe_u32 v177, v176, 16, 1
  v_cmp_ne_u32 vcc, 0, v177
  s_andn2_b64 s[76:77], s[76:77], vcc
  s_andn2_b64 s[78:79], s[78:79], vcc
  s_andn2_b64 s[80:81], s[80:81], vcc
  v_bfe_u32 v177, v176, 24, 1
  v_cmp_ne_u32 vcc, 0, v177
  s_andn2_b64 s[82:83], s[82:83], vcc
  s_andn2_b64 s[84:85], s[84:85], vcc
  s_andn2_b64 s[86:87], s[86:87], vcc
  s_branch L_arrived
L_empty:
  s_barrier
  s_branch L_fin
L_newgrp:
  s_lshl_b32 s57, s10, 7
  v_cmp_ge_u32 vcc, s57, v0
  s_and_b32 s56, vcc_lo, 0x80808080
  s_bcnt1_i32_b32 s58, s56
  s_lshl3_add_u32 s56, s58, 7
  v_readlane_b32 s15, v0, s56
  s_lshl_b32 s56, s58, 10
  v_lshl_add_u32 v211, v1, 3, s56
  s_lshr_b32 s15, s15, 7
  ds_read_b64 v[36:37], v211 offset:1408
  ds_read_b64 v[40:41], v211 offset:1920
  s_sub_u32 s56, s58, s12
  s_lshl_b32 s56, s56, 29
  s_add_u32 s17, s17, s56
  s_mov_b32 s12, s58
  s_branch L_newgrp_back
L_flush:
  s_add_u32 s57, s13, s63
  s_mul_i32 s56, s57, 2432
  v_add_u32 v211, s56, v209
  v_add_u32 v214, s56, v210
  s_lshl_b32 s57, 1, s57
  s_lshl_b32 s56, s13, 2
  v_mov_b32 v194, s56
  v_mov_b32 v195, s57
  s_mov_b64 exec, 1
  ds_or_b32 v194, v195 offset:1376
  s_mov_b32 exec_lo, 0x11111111
  s_mov_b32 exec_hi, 0x11111111
  ds_write_b128 v211, v[64:67] offset:0
  ds_write_b128 v211, v[68:71] offset:32
  ds_write_b128 v211, v[72:75] offset:64
  ds_write_b128 v211, v[76:79] offset:96
  s_mov_b64 exec, -1
  v_pk_mul_f32 v[2:3], v[216:217], v[64:65]
  v_pk_mul_f32 v[192:193], v[218:219], v[66:67]
  v_pk_fma_f32 v[2:3], v[220:221], v[68:69], v[2:3]
  v_pk_fma_f32 v[192:193], v[222:223], v[70:71], v[192:193]
  v_pk_fma_f32 v[2:3], v[224:225], v[72:73], v[2:3]
  v_pk_fma_f32 v[192:193], v[226:227], v[74:75], v[192:193]
  v_pk_fma_f32 v[2:3], v[228:229], v[76:77], v[2:3]
  v_pk_fma_f32 v[192:193], v[230:231], v[78:79], v[192:193]
  v_mfma_f32_32x32x16_bf16 v[64:79], v[188:191], v[188:191], 0
  s_mov_b32 exec_lo, 0x11111111
  s_mov_b32 exec_hi, 0x11111111
  ds_write_b128 v211, v[80:83] offset:128
  ds_write_b128 v211, v[84:87] offset:160
  ds_write_b128 v211, v[88:91] offset:192
  ds_write_b128 v211, v[92:95] offset:224
  s_mov_b64 exec, -1
  v_pk_fma_f32 v[2:3], v[232:233], v[80:81], v[2:3]
  v_pk_fma_f32 v[192:193], v[234:235], v[82:83], v[192:193]
  v_pk_fma_f32 v[2:3], v[236:237], v[84:85], v[2:3]
  v_pk_fma_f32 v[192:193], v[238:239], v[86:87], v[192:193]
  v_pk_fma_f32 v[2:3], v[240:241], v[88:89], v[2:3]
  v_pk_fma_f32 v[192:193], v[242:243], v[90:91], v[192:193]
  v_pk_fma_f32 v[2:3], v[244:245], v[92:93], v[2:3]
  v_pk_fma_f32 v[192:193], v[246:247], v[94:95], v[192:193]
  v_mfma_f32_32x32x16_bf16 v[80:95], v[188:191], v[188:191], 0
  v_pk_add_f32 v[2:3], v[2:3], v[192:193]
  v_add_f32 v2, v2, v3
  ds_write_b32 v214, v2
  s_mov_b32 s13, s12
  s_branch L_flush_back
L_extA:
  v_and_b32_sdwa v136, v172, s59 dst_sel:DWORD dst_unused:UNUSED_PAD src0_sel:BYTE_3 src1_sel:DWORD
  v_and_b32_sdwa v137, v173, s59 dst_sel:DWORD dst_unused:UNUSED_PAD src0_sel:BYTE_3 src1_sel:DWORD
  v_and_b32_sdwa v138, v174, s59 dst_sel:DWORD dst_unused:UNUSED_PAD src0_sel:BYTE_3 src1_sel:DWORD
  s_mov_b64 exec, s[88:89]
  ds_add_rtn_u32 v151, v136, v2 offset:0
  s_mov_b64 exec, s[90:91]
  ds_add_rtn_u32 v152, v137, v2 offset:0
  s_mov_b64 exec, s[92:93]
  ds_add_rtn_u32 v153, v138, v2 offset:0
  s_mov_b64 exec, -1
  s_branch L_extA_back
L_extB:
  ds_bpermute_b32 v136, v136, v176
  ds_bpermute_b32 v137, v137, v176
  ds_bpermute_b32 v138, v138, v176
  s_waitcnt lgkmcnt(0)
  s_mov_b64 exec, s[88:89]
  v_add_u32 v136, v136, v151
  ds_write2st64_b32 v136, v172, v155 offset0:28 offset1:76
  s_mov_b64 exec, s[90:91]
  v_add_u32 v137, v137, v152
  ds_write2st64_b32 v137, v173, v155 offset0:28 offset1:76
  s_mov_b64 exec, s[92:93]
  v_add_u32 v138, v138, v153
  ds_write2st64_b32 v138, v174, v155 offset0:28 offset1:76
  s_mov_b64 exec, -1
  s_branch L_extB_back
L_store4:
  s_mov_b64 exec, vcc
  ds_read2_b32 v[168:169], v15 offset0:0 offset1:1
  ds_read_b32 v170, v15 offset:8
  s_waitcnt lgkmcnt(0)
  buffer_store_dwordx4 v[168:171], v12, s[36:39], s9 offen sc1
  s_mov_b64 exec, -1
  s_branch L_store4_back
L_ext:
  s_mov_b32 exec_lo, 65535
  s_mov_b32 exec_hi, 0
  v_mov_b32 v176, s68
  v_mov_b32 v177, s69
  s_mov_b32 exec_lo, 4294901760
  s_mov_b32 exec_hi, 0
  v_mov_b32 v176, s74
  v_mov_b32 v177, s75
  s_mov_b32 exec_lo, 0
  s_mov_b32 exec_hi, 65535
  v_mov_b32 v176, s80
  v_mov_b32 v177, s81
  s_mov_b32 exec_lo, 0
  s_mov_b32 exec_hi, 4294901760
  v_mov_b32 v176, s86
  v_mov_b32 v177, s87
  s_mov_b64 exec, -1
  v_bfe_u32 v178, v1, 1, 3
  v_lshl_or_b32 v178, v178, 3, 7
  v_lshrrev_b64 v[176:177], v178, v[176:177]
  v_and_b32 v176, 1, v176
  v_cmp_ne_u32 s[4:5], 0, v176
  s_lshl_b32 s6, s3, 5
  v_lshrrev_b32 v177, 1, v1
  v_add_u32 v177, s6, v177
  s_movk_i32 s6, 2500
  v_mul_u32_u24 v155, s6, v177
  s_mov_b32 s6, 41088
  v_mul_u32_u24 v154, s6, v177
  v_and_b32 v177, 1, v1
  v_lshl_add_u32 v154, v177, 4, v154
  s_lshl_b32 s6, s26, 5
  s_add_u32 s6, s6, 32768
  s_mov_b32 s7, 0
  s_mov_b32 s12, 0x55555555
  s_mov_b32 s13, 0x55555555
L_ext2:
  s_mov_b64 exec, s[4:5]
  buffer_load_dwordx4 v[172:175], v154, s[36:39], s6 offen sc1
  s_waitcnt vmcnt(0)
  v_cmpx_eq_u32 s[8:9], s44, v175
  v_cmpx_gt_u32 s[88:89], s95, v172
  v_cmpx_gt_u32 s[90:91], s95, v173
  v_cmpx_gt_u32 s[92:93], s95, v174
  s_lshl_b64 s[10:11], s[92:93], 1
  s_or_b64 s[10:11], s[10:11], s[12:13]
  s_and_b64 s[10:11], s[10:11], s[4:5]
  s_andn2_b64 s[10:11], s[10:11], s[8:9]
  s_cbranch_scc0 L_ext3
  s_add_u32 s7, s7, 1
  s_cmp_lt_u32 s7, 3000
  s_cbranch_scc1 L_ext2
L_ext3:
  s_andn2_b64 s[8:9], s[92:93], s[12:13]
  s_or_b64 s[10:11], s[10:11], s[8:9]
  s_mov_b32 s46, 1
  s_mov_b64 exec, -1
  s_cbranch_scc0 L_hj
  s_lshr_b64 s[8:9], s[10:11], 1
  s_or_b64 s[10:11], s[10:11], s[8:9]
  s_and_b64 s[10:11], s[10:11], s[12:13]
  s_lshl_b64 s[8:9], s[10:11], 1
  s_or_b64 s[10:11], s[10:11], s[8:9]
  s_andn2_b64 s[88:89], s[88:89], s[10:11]
  s_andn2_b64 s[90:91], s[90:91], s[10:11]
  s_andn2_b64 s[92:93], s[92:93], s[10:11]
  s_lshl_b32 s14, s3, 2
  v_lshrrev_b32 v176, 1, v1
  s_mov_b64 exec, s[10:11]
  v_lshlrev_b32 v176, v176, 1
  v_mov_b32 v177, s14
  ds_or_b32 v177, v176 offset:1344
  s_mov_b64 exec, -1
  s_lshl_b32 s14, s3, 2
  v_mov_b32 v177, s14
  s_waitcnt lgkmcnt(0)
  ds_read_b32 v176, v177 offset:1344
  v_lshrrev_b32 v177, 3, v1
  s_waitcnt lgkmcnt(0)
  v_lshrrev_b32 v176, v177, v176
  v_bfe_u32 v177, v176, 0, 1
  v_cmp_ne_u32 vcc, 0, v177
  s_andn2_b64 s[64:65], s[64:65], vcc
  s_andn2_b64 s[66:67], s[66:67], vcc
  s_andn2_b64 s[68:69], s[68:69], vcc
  v_bfe_u32 v177, v176, 8, 1
  v_cmp_ne_u32 vcc, 0, v177
  s_andn2_b64 s[70:71], s[70:71], vcc
  s_andn2_b64 s[72:73], s[72:73], vcc
  s_andn2_b64 s[74:75], s[74:75], vcc
  v_bfe_u32 v177, v176, 16, 1
  v_cmp_ne_u32 vcc, 0, v177
  s_andn2_b64 s[76:77], s[76:77], vcc
  s_andn2_b64 s[78:79], s[78:79], vcc
  s_andn2_b64 s[80:81], s[80:81], vcc
  v_bfe_u32 v177, v176, 24, 1
  v_cmp_ne_u32 vcc, 0, v177
  s_andn2_b64 s[82:83], s[82:83], vcc
  s_andn2_b64 s[84:85], s[84:85], vcc
  s_andn2_b64 s[86:87], s[86:87], vcc
  s_branch L_hj
L_bump:
  s_cmp_lg_u32 s3, 7
  s_cbranch_scc1 L_bump_back
  s_cmp_lg_u32 s19, 0
  s_cselect_b32 s55, 1, 0
  s_cbranch_scc1 L_bump_back
  v_mov_b32 v211, 0
  v_mov_b32 v214, s44
  s_mov_b64 exec, 1
  buffer_store_dword v214, v211, s[36:39], s100 offen sc1
  s_mov_b64 exec, -1
  s_branch L_bump_back
L_latebump:
  s_mov_b64 exec, -1
  s_mov_b32 s4, 41088
  v_mul_u32_u24 v2, s4, v1
  s_mov_b32 s5, 0
  s_mov_b32 s6, 2629632
  s_mov_b32 s7, 5259264
  s_mov_b32 s8, 7888896
L_lb1:
  buffer_load_dword v4, v2, s[36:39], 0 offen offset:12 sc1
  buffer_load_dword v5, v2, s[36:39], s6 offen offset:12 sc1
  buffer_load_dword v6, v2, s[36:39], s7 offen offset:12 sc1
  buffer_load_dword v7, v2, s[36:39], s8 offen offset:12 sc1
  s_waitcnt vmcnt(0)
  v_xor_b32 v4, s44, v4
  v_xor_b32 v5, s44, v5
  v_xor_b32 v6, s44, v6
  v_xor_b32 v7, s44, v7
  v_or3_b32 v4, v4, v5, v6
  v_or_b32 v4, v4, v7
  v_cmp_ne_u32 vcc, 0, v4
  s_cbranch_vccz L_lb2
  s_sleep 8
  s_add_u32 s5, s5, 1
  s_cmp_lt_u32 s5, 0x40000
  s_cbranch_scc1 L_lb1
L_lb2:
  v_mov_b32 v211, 0
  v_mov_b32 v214, s44
  s_mov_b64 exec, 1
  buffer_store_dword v214, v211, s[36:39], s100 offen sc1
  s_mov_b64 exec, -1
  s_branch L_latebump_back
L_more:
  v_ffbl_b32 v2, v71
  v_add_u32 v3, -1, v71
  v_mad_u32_u24 v2, v2, s18, v68
  v_and_b32 v71, v3, v71
  ds_read_b128 v[88:91], v2 offset:0
  ds_read_b128 v[92:95], v2 offset:16
  ds_read_b128 v[96:99], v2 offset:128
  ds_read_b128 v[100:103], v2 offset:144
  v_cmp_ne_u32 vcc, 0, v71
  s_waitcnt lgkmcnt(0)
  v_add_f32 v72, v72, v88
  v_add_f32 v73, v73, v89
  v_add_f32 v74, v74, v90
  v_add_f32 v75, v75, v91
  v_add_f32 v76, v76, v92
  v_add_f32 v77, v77, v93
  v_add_f32 v78, v78, v94
  v_add_f32 v79, v79, v95
  v_add_f32 v80, v80, v96
  v_add_f32 v81, v81, v97
  v_add_f32 v82, v82, v98
  v_add_f32 v83, v83, v99
  v_add_f32 v84, v84, v100
  v_add_f32 v85, v85, v101
  v_add_f32 v86, v86, v102
  v_add_f32 v87, v87, v103
  s_cbranch_vccnz L_more
  s_branch L_more_back
L_gate:
  s_cmp_eq_u32 s54, 0
  s_cbranch_scc1 L_gate0
  s_mov_b64 s[64:65], 0
  s_mov_b64 s[66:67], 0
  s_mov_b64 s[68:69], 0
L_gate0:
  s_cmp_eq_u32 s54, 1
  s_cbranch_scc1 L_gate1
  s_mov_b64 s[70:71], 0
  s_mov_b64 s[72:73], 0
  s_mov_b64 s[74:75], 0
L_gate1:
  s_cmp_eq_u32 s54, 2
  s_cbranch_scc1 L_gate2
  s_mov_b64 s[76:77], 0
  s_mov_b64 s[78:79], 0
  s_mov_b64 s[80:81], 0
L_gate2:
  s_cmp_eq_u32 s54, 3
  s_cbranch_scc1 L_gate3
  s_mov_b64 s[82:83], 0
  s_mov_b64 s[84:85], 0
  s_mov_b64 s[86:87], 0
L_gate3:
  s_cmp_eq_u32 s54, 4
  s_cselect_b32 s46, s46, 0
L_gcount:
  v_and_b32_sdwa v124, v156, s59 dst_sel:DWORD dst_unused:UNUSED_PAD src0_sel:BYTE_3 src1_sel:DWORD
  v_and_b32_sdwa v125, v157, s59 dst_sel:DWORD dst_unused:UNUSED_PAD src0_sel:BYTE_3 src1_sel:DWORD
  v_and_b32_sdwa v126, v158, s59 dst_sel:DWORD dst_unused:UNUSED_PAD src0_sel:BYTE_3 src1_sel:DWORD
  v_and_b32_sdwa v127, v160, s59 dst_sel:DWORD dst_unused:UNUSED_PAD src0_sel:BYTE_3 src1_sel:DWORD
  v_and_b32_sdwa v128, v161, s59 dst_sel:DWORD dst_unused:UNUSED_PAD src0_sel:BYTE_3 src1_sel:DWORD
  v_and_b32_sdwa v129, v162, s59 dst_sel:DWORD dst_unused:UNUSED_PAD src0_sel:BYTE_3 src1_sel:DWORD
  v_and_b32_sdwa v130, v164, s59 dst_sel:DWORD dst_unused:UNUSED_PAD src0_sel:BYTE_3 src1_sel:DWORD
  v_and_b32_sdwa v131, v165, s59 dst_sel:DWORD dst_unused:UNUSED_PAD src0_sel:BYTE_3 src1_sel:DWORD
  v_and_b32_sdwa v132, v166, s59 dst_sel:DWORD dst_unused:UNUSED_PAD src0_sel:BYTE_3 src1_sel:DWORD
  v_and_b32_sdwa v133, v168, s59 dst_sel:DWORD dst_unused:UNUSED_PAD src0_sel:BYTE_3 src1_sel:DWORD
  v_and_b32_sdwa v134, v169, s59 dst_sel:DWORD dst_unused:UNUSED_PAD src0_sel:BYTE_3 src1_sel:DWORD
  v_and_b32_sdwa v135, v170, s59 dst_sel:DWORD dst_unused:UNUSED_PAD src0_sel:BYTE_3 src1_sel:DWORD
  s_mov_b64 exec, s[64:65]
  ds_add_rtn_u32 v139, v124, v2 offset:0
  s_mov_b64 exec, s[66:67]
  ds_add_rtn_u32 v140, v125, v2 offset:0
  s_mov_b64 exec, s[68:69]
  ds_add_rtn_u32 v141, v126, v2 offset:0
  s_mov_b64 exec, s[70:71]
  ds_add_rtn_u32 v142, v127, v2 offset:0
  s_mov_b64 exec, s[72:73]
  ds_add_rtn_u32 v143, v128, v2 offset:0
  s_mov_b64 exec, s[74:75]
  ds_add_rtn_u32 v144, v129, v2 offset:0
  s_mov_b64 exec, s[76:77]
  ds_add_rtn_u32 v145, v130, v2 offset:0
  s_mov_b64 exec, s[78:79]
  ds_add_rtn_u32 v146, v131, v2 offset:0
  s_mov_b64 exec, s[80:81]
  ds_add_rtn_u32 v147, v132, v2 offset:0
  s_mov_b64 exec, s[82:83]
  ds_add_rtn_u32 v148, v133, v2 offset:0
  s_mov_b64 exec, s[84:85]
  ds_add_rtn_u32 v149, v134, v2 offset:0
  s_mov_b64 exec, s[86:87]
  ds_add_rtn_u32 v150, v135, v2 offset:0
  s_mov_b64 exec, -1
  s_branch L_cnt_done
L_goslow:
  s_mov_b32 s53, 1
  s_mov_b32 s97, -1
  s_mov_b32 s98, 0
  s_mov_b32 s99, 4
  s_cmp_gt_u32 s20, 11776
  s_cbranch_scc0 L_goslow_back
  s_waitcnt lgkmcnt(0)
  s_mov_b32 s54, 0
  s_barrier
  s_branch L_round
L_slow_n:
  s_lshl_b32 s16, s16, 12
  s_add_u32 s16, s16, 39936
  v_lshl_add_u32 v67, v1, 4, s16
  s_cmp_lt_u32 s53, 2
  s_cbranch_scc1 L_slow_n1
  ds_read_b128 v[88:91], v67 offset:0
  ds_read_b128 v[92:95], v67 offset:1024
  ds_read_b128 v[96:99], v67 offset:2048
  ds_read_b128 v[100:103], v67 offset:3072
  s_waitcnt lgkmcnt(0)
  v_add_f32 v72, v72, v88
  v_add_f32 v73, v73, v89
  v_add_f32 v74, v74, v90
  v_add_f32 v75, v75, v91
  v_add_f32 v76, v76, v92
  v_add_f32 v77, v77, v93
  v_add_f32 v78, v78, v94
  v_add_f32 v79, v79, v95
  v_add_f32 v80, v80, v96
  v_add_f32 v81, v81, v97
  v_add_f32 v82, v82, v98
  v_add_f32 v83, v83, v99
  v_add_f32 v84, v84, v100
  v_add_f32 v85, v85, v101
  v_add_f32 v86, v86, v102
  v_add_f32 v87, v87, v103
L_slow_n1:
  s_add_u32 s54, s54, 1
  s_cmp_lt_u32 s54, 5
  s_cbranch_scc1 L_adv_gon
  s_mov_b32 s54, 8
  s_add_u32 s99, s99, 1
  s_cmp_lt_u32 s99, 5
  s_cbranch_scc1 L_adv_gon
  ds_read_b32 v2, v248 offset:1344
  s_mov_b32 s99, 0
  s_sub_u32 s6, s98, 1
  s_and_b32 s98, s98, s6
  s_waitcnt lgkmcnt(0)
L_adv_wn:
  s_cmp_lg_u32 s98, 0
  s_cbranch_scc1 L_adv_gon
  s_add_u32 s97, s97, 1
  s_cmp_ge_u32 s97, 8
  s_cbranch_scc1 L_final_n
  v_readlane_b32 s98, v2, s97
  s_branch L_adv_wn
L_adv_gon:
  s_barrier
  s_bitcmp1_b32 s3, 0
  s_cbranch_scc1 L_round0
  ds_write_b128 v67, v[72:75] offset:0
  ds_write_b128 v67, v[76:79] offset:1024
  ds_write_b128 v67, v[80:83] offset:2048
  ds_write_b128 v67, v[84:87] offset:3072
  s_branch L_round0
L_slow_p:
  v_lshlrev_b32 v67, 2, v64
  v_add_u32 v67, 52224, v67
  s_cmp_lt_u32 s53, 2
  s_cbranch_scc1 L_slow_p1
  ds_read_b32 v88, v67
  s_waitcnt lgkmcnt(0)
  v_add_f32 v72, v72, v88
L_slow_p1:
  s_add_u32 s54, s54, 1
  s_cmp_lt_u32 s54, 5
  s_cbranch_scc1 L_adv_gop
  s_mov_b32 s54, 8
  s_add_u32 s99, s99, 1
  s_cmp_lt_u32 s99, 5
  s_cbranch_scc1 L_adv_gop
  ds_read_b32 v2, v248 offset:1344
  s_mov_b32 s99, 0
  s_sub_u32 s6, s98, 1
  s_and_b32 s98, s98, s6
  s_waitcnt lgkmcnt(0)
L_adv_wp:
  s_cmp_lg_u32 s98, 0
  s_cbranch_scc1 L_adv_gop
  s_add_u32 s97, s97, 1
  s_cmp_ge_u32 s97, 8
  s_cbranch_scc1 L_final_p
  v_readlane_b32 s98, v2, s97
  s_branch L_adv_wp
L_adv_gop:
  s_barrier
  ds_write_b32 v67, v72
L_round0:
  s_mov_b32 s53, 3
  v_lshlrev_b32 v2, 4, v1
  s_lshl_b32 s57, s3, 10
  s_add_u32 s56, s57, 0
  s_add_u32 m0, s56, 97280
  s_nop 0
  buffer_load_dwordx4 v2, s[40:43], s56 offen lds
  s_add_u32 s56, s57, 8192
  s_add_u32 m0, s56, 97280
  s_nop 0
  buffer_load_dwordx4 v2, s[40:43], s56 offen lds
  s_add_u32 s56, s57, 16384
  s_add_u32 m0, s56, 97280
  s_nop 0
  buffer_load_dwordx4 v2, s[40:43], s56 offen lds
  s_add_u32 s56, s57, 24576
  s_add_u32 m0, s56, 97280
  s_nop 0
  buffer_load_dwordx4 v2, s[40:43], s56 offen lds
  s_add_u32 s56, s57, 32768
  s_add_u32 m0, s56, 97280
  s_nop 0
  buffer_load_dwordx4 v2, s[40:43], s56 offen lds
  s_add_u32 s56, s57, 40960
  s_add_u32 m0, s56, 97280
  s_nop 0
  buffer_load_dwordx4 v2, s[40:43], s56 offen lds
  s_add_u32 s56, s57, 49152
  s_add_u32 m0, s56, 97280
  s_nop 0
  buffer_load_dwordx4 v2, s[40:43], s56 offen lds
  s_add_u32 s56, s57, 57344
  s_min_u32 s56, s56, 59392
  s_add_u32 m0, s56, 97280
  s_nop 0
  buffer_load_dwordx4 v2, s[40:43], s56 offen lds
L_round:
  v_lshrrev_b32 v211, 3, v1
  v_lshlrev_b32 v60, 4, v211
  v_add_u32 v60, 7168, v60
  v_bfe_u32 v211, v1, 2, 2
  v_lshrrev_b32 v214, 5, v1
  v_lshl_add_u32 v211, v214, 2, v211
  v_lshlrev_b32 v61, 4, v211
  v_add_u32 v61, 7168, v61
  v_bfe_u32 v211, v1, 4, 1
  v_and_b32 v214, 3, v1
  v_lshl_add_u32 v211, v211, 2, v214
  v_lshl_or_b32 v197, v211, 26, v61
  v_and_b32 v211, 31, v1
  v_lshlrev_b32 v62, 4, v211
  s_lshl_b32 s56, s3, 8
  s_add_u32 s56, s56, 157696
  v_lshl_add_u32 v63, v211, 3, s56
  v_add_u32 v214, 7172, v62
  v_cndmask_b32 v63, v63, v214, s[60:61]
  v_lshrrev_b32 v211, 1, v1
  v_lshlrev_b32 v250, 4, v211
  s_mov_b32 s18, s56
  v_mov_b32 v180, 0
  s_mov_b32 exec_lo, 0x80808080
  s_mov_b32 exec_hi, 0x80808080
  v_mov_b32 v180, 0x7f
  s_mov_b64 exec, -1
  s_lshl3_add_u32 s21, s3, 7
  s_lshl_b32 s16, s3, 12
  s_add_u32 s16, s16, 56320
  v_mov_b32 v182, s95
  v_mov_b32 v183, 0
  v_lshrrev_b32 v186, 2, v60
  v_lshrrev_b32 v187, 2, v250
  v_add_u32 v186, 5376, v186
  s_mov_b32 s22, 0x01010101
  s_mov_b32 s23, 0x01010101
  v_mov_b32 v188, v249
  v_add_u32 v189, 20000, v249
  v_add_u32 v190, 40000, v249
  v_add_u32 v191, 60000, v249
  v_mov_b32 v64, 0
  v_mov_b32 v65, 0
  v_mov_b32 v66, 0
  v_mov_b32 v67, 0
  v_mov_b32 v68, 0
  v_mov_b32 v69, 0
  v_mov_b32 v70, 0
  v_mov_b32 v71, 0
  v_mov_b32 v72, 0
  v_mov_b32 v73, 0
  v_mov_b32 v74, 0
  v_mov_b32 v75, 0
  v_mov_b32 v76, 0
  v_mov_b32 v77, 0
  v_mov_b32 v78, 0
  v_mov_b32 v79, 0
  v_mov_b32 v80, 0
  v_mov_b32 v81, 0
  v_mov_b32 v82, 0
  v_mov_b32 v83, 0
  v_mov_b32 v84, 0
  v_mov_b32 v85, 0
  v_mov_b32 v86, 0
  v_mov_b32 v87, 0
  v_mov_b32 v88, 0
  v_mov_b32 v89, 0
  v_mov_b32 v90, 0
  v_mov_b32 v91, 0
  v_mov_b32 v92, 0
  v_mov_b32 v93, 0
  v_mov_b32 v94, 0
  v_mov_b32 v95, 0
  v_mov_b32 v3, 0
  ds_write_b32 v248, v3 offset:0
  s_mov_b64 exec, 0xff
  ds_write_b32 v248, v3 offset:1376
  s_mov_b64 exec, -1
  v_mov_b32 v2, 4
  s_cmp_ge_u32 s54, 8
  s_cbranch_scc1 L_rawround
  buffer_load_dwordx4 v[156:159], v215, s[36:39], 0 offen sc1
  s_mov_b32 s56, 328704
  buffer_load_dwordx4 v[160:163], v215, s[36:39], s56 offen sc1
  s_mov_b32 s56, 657408
  buffer_load_dwordx4 v[164:167], v215, s[36:39], s56 offen sc1
  s_mov_b32 s56, 986112
  buffer_load_dwordx4 v[168:171], v215, s[36:39], s56 offen sc1
  s_waitcnt vmcnt(0) lgkmcnt(0)
  v_cmpx_eq_u32 s[4:5], s44, v159
  v_cmpx_gt_u32 s[64:65], s95, v156
  v_cmpx_gt_u32 s[66:67], s95, v157
  v_cmpx_gt_u32 s[68:69], s95, v158
  s_mov_b64 exec, -1
  v_cmpx_eq_u32 s[6:7], s44, v163
  v_cmpx_gt_u32 s[70:71], s95, v160
  v_cmpx_gt_u32 s[72:73], s95, v161
  v_cmpx_gt_u32 s[74:75], s95, v162
  s_mov_b64 exec, -1
  v_cmpx_eq_u32 s[8:9], s44, v167
  v_cmpx_gt_u32 s[76:77], s95, v164
  v_cmpx_gt_u32 s[78:79], s95, v165
  v_cmpx_gt_u32 s[80:81], s95, v166
  s_mov_b64 exec, -1
  v_cmpx_eq_u32 s[10:11], s44, v171
  v_cmpx_gt_u32 s[82:83], s95, v168
  v_cmpx_gt_u32 s[84:85], s95, v169
  v_cmpx_gt_u32 s[86:87], s95, v170
  s_mov_b64 exec, -1
  s_mov_b64 exec, -1
  s_lshl_b32 s14, s3, 2
  v_mov_b32 v177, s14
  s_waitcnt lgkmcnt(0)
  ds_read_b32 v176, v177 offset:1344
  v_lshrrev_b32 v177, 3, v1
  s_waitcnt lgkmcnt(0)
  v_lshrrev_b32 v176, v177, v176
  v_bfe_u32 v177, v176, 0, 1
  v_cmp_ne_u32 vcc, 0, v177
  s_andn2_b64 s[64:65], s[64:65], vcc
  s_andn2_b64 s[66:67], s[66:67], vcc
  s_andn2_b64 s[68:69], s[68:69], vcc
  v_bfe_u32 v177, v176, 8, 1
  v_cmp_ne_u32 vcc, 0, v177
  s_andn2_b64 s[70:71], s[70:71], vcc
  s_andn2_b64 s[72:73], s[72:73], vcc
  s_andn2_b64 s[74:75], s[74:75], vcc
  v_bfe_u32 v177, v176, 16, 1
  v_cmp_ne_u32 vcc, 0, v177
  s_andn2_b64 s[76:77], s[76:77], vcc
  s_andn2_b64 s[78:79], s[78:79], vcc
  s_andn2_b64 s[80:81], s[80:81], vcc
  v_bfe_u32 v177, v176, 24, 1
  v_cmp_ne_u32 vcc, 0, v177
  s_andn2_b64 s[82:83], s[82:83], vcc
  s_andn2_b64 s[84:85], s[84:85], vcc
  s_andn2_b64 s[86:87], s[86:87], vcc
  s_barrier
  s_branch L_arrived
L_rawround:
  s_mov_b32 s46, 0
  s_mov_b64 s[66:67], 0
  s_mov_b64 s[68:69], 0
  s_mov_b64 s[70:71], 0
  s_mov_b64 s[72:73], 0
  s_mov_b64 s[74:75], 0
  s_mov_b64 s[76:77], 0
  s_mov_b64 s[78:79], 0
  s_mov_b64 s[80:81], 0
  s_mov_b64 s[82:83], 0
  s_mov_b64 s[84:85], 0
  s_mov_b64 s[86:87], 0
  s_load_dwordx4 s[4:7], s[0:1], 24
  s_ff1_i32_b32 s56, s98
  s_lshl_b32 s57, s97, 5
  s_add_u32 s56, s56, s57
  s_mul_i32 s57, s56, 2500
  v_mov_b32 v188, s57
  s_lshl_b32 s57, s57, 2
  s_lshl_b32 s58, s99, 3
  s_add_u32 s58, s58, s3
  s_lshl_b32 s58, s58, 6
  v_add_u32 v177, s58, v1
  v_lshlrev_b32 v3, 2, v177
  s_waitcnt lgkmcnt(0)
  s_mov_b32 s8, s4
  s_mov_b32 s9, s5
  s_mov_b32 s10, 2560000
  s_mov_b32 s11, 0x20000
  s_mov_b32 s12, s6
  s_mov_b32 s13, s7
  s_mov_b32 s14, 2560000
  s_mov_b32 s15, 0x20000
  buffer_load_dword v178, v3, s[12:15], s57 offen
  buffer_load_dword v156, v3, s[8:11], s57 offen
  s_movk_i32 s4, 2500
  v_cmp_gt_u32 s[6:7], s4, v177
  s_mov_b32 s5, 6871948
  s_waitcnt vmcnt(0)
  v_lshl_or_b32 v3, v178, 4, 15
  v_mul_hi_u32 v3, v3, s5
  v_subrev_u32 v178, s27, v178
  v_cmp_eq_u32 s[64:65], s26, v3
  v_lshl_or_b32 v156, v177, 14, v156
  v_lshl_or_b32 v156, v178, 26, v156
  s_and_b64 s[64:65], s[64:65], s[6:7]
  s_barrier
  s_branch L_gcount
L_code_end:
.section .rodata,"a"
.p2align 6
.amdhsa_kernel gather_scatter__cheap_equivariant_egnn__graph_kernel
  .amdhsa_next_free_vgpr 256
  .amdhsa_next_free_sgpr 102
  .amdhsa_accum_offset 256
  .amdhsa_group_segment_fixed_size 0
  .amdhsa_kernarg_size 88
  .amdhsa_user_sgpr_count 2
  .amdhsa_user_sgpr_kernarg_segment_ptr 1
  .amdhsa_system_sgpr_workgroup_id_x 1
  .amdhsa_float_denorm_mode_32 3
.end_amdhsa_kernel
```
